```python
import torch

def _softmax(x, axis=-1):
    return torch.softmax(x, dim=axis)

def _gelu(x):
    return torch.nn.functional.gelu(x, approximate='tanh')

def _silu(x):
    return torch.nn.functional.silu(x)

def _sigmoid(x):
    return torch.sigmoid(x)

def _layernorm(x, axis=-1, eps=1e-05):
    m = x.mean(dim=axis, keepdim=True)
    v = x.var(dim=axis, keepdim=True, unbiased=False)
    return (x - m) / torch.sqrt(v + eps)

def _scatter_add(tgt, idx, src, axis=0):
    return tgt.clone().index_add_(axis, idx, src)

def _segment_sum(src, seg, n):
    out = torch.zeros((n,) + src.shape[1:], dtype=src.dtype)
    return out.index_add_(0, seg, src)

def _pad(x, pw):
    flat = tuple((v for pair in reversed(pw) for v in pair))
    return torch.nn.functional.pad(x, flat)
kernel_name = 'adaLN_cond__ssm_conv_h3__glu_gated_bilinear__prompt'

def setup_inputs():

    _w = lambda a: (lambda t: t.to(torch.bfloat16) if t.is_floating_point() else t)(torch.as_tensor(a))

    def _A_setup():
        B, S, D = (1, 2048, 512)
        ks = 4
        return {'q': _w((lambda *s: torch.randn(*s, dtype=torch.bfloat16) * 0.05)(B, S, D)), 'k': _w((lambda *s: torch.randn(*s, dtype=torch.bfloat16) * 0.8)(B, S, D)), 'v': _w((lambda *s: torch.randn(*s, dtype=torch.bfloat16) * 0.8)(B, S, D)), 'shift_k': _w((lambda *s: torch.randn(*s, dtype=torch.bfloat16) * 0.8)(D, ks) * 0.5), 'ssm_k': _w((lambda *s: torch.randn(*s, dtype=torch.bfloat16) * 0.8)(D, S) * (1.0 / S ** 0.5)), 'ssm_D': _w((lambda *s: torch.randn(*s, dtype=torch.bfloat16) * 0.8)(D))}
    _A_in = _A_setup()

    def _B_setup():
        B, S, D, F = (1, 2048, 512, 1792)
        return {'x': _w((lambda *s: torch.randn(*s, dtype=torch.bfloat16) * 0.05)(B, S, D)), 'w_gate': _w((lambda *s: torch.randn(*s, dtype=torch.bfloat16) * 0.8)(D, F) * D ** (-0.5)), 'w_up': _w((lambda *s: torch.randn(*s, dtype=torch.bfloat16) * 0.8)(D, F) * D ** (-0.5)), 'w_down': _w((lambda *s: torch.randn(*s, dtype=torch.bfloat16) * 0.8)(F, D) * F ** (-0.5))}
    _B_in = _B_setup()
    return {'A_q': _A_in['q'], 'A_k': _A_in['k'], 'A_v': _A_in['v'], 'A_shift_k': _A_in['shift_k'], 'A_ssm_k': _A_in['ssm_k'], 'A_ssm_D': _A_in['ssm_D'], 'B_x': _B_in['x'], 'B_w_gate': _B_in['w_gate'], 'B_w_up': _B_in['w_up'], 'B_w_down': _B_in['w_down'], 'c': _w((lambda *s: torch.randn(*s, dtype=torch.bfloat16) * 0.2)(1, 512) * 8.0), 'w_mod': _w((lambda *s: torch.randn(*s, dtype=torch.bfloat16) * 0.2)(512, 6 * 512) * 512 ** (-0.5) * 8.0)}

def reference(A_q, A_k, A_v, A_shift_k, A_ssm_k, A_ssm_D, B_x, B_w_gate, B_w_up, B_w_down, c, w_mod):

    def _A_ref(q, k, v, shift_k, ssm_k, ssm_D):
        B, S, D = q.shape
        ks = shift_k.shape[-1]
        k_pad = _pad(k, ((0, 0), (ks - 1, 0), (0, 0)))
        k_shift = torch.zeros_like(k)
        for t in range(ks):
            k_shift = k_shift + k_pad[:, t:t + S, :] * shift_k[:, ks - 1 - t][None, None, :]
        kv = k_shift * v
        L = 2 * S
        kv_pad = _pad(kv, ((0, 0), (0, S), (0, 0)))
        kf_pad = _pad(ssm_k, ((0, 0), (0, S)))
        kv_f = (lambda x, axes=(-2, -1): torch.fft.rfft2(x.float(), dim=axes))(kv_pad[:, None, :, :], axes=(1, 2))
        kf_f = (lambda x, axes=(-2, -1): torch.fft.rfft2(x.float(), dim=axes))(kf_pad[:, None, :], axes=(1, 2))
        kf_f = (lambda x, *d: x.permute(*d))(kf_f, 1, 2, 0)
        y_f = kv_f * kf_f[None, :, :, :]
        y = (lambda x, s, axes=(-2, -1): torch.fft.irfft2(x, s=s, dim=axes).to(torch.bfloat16))(y_f, (1, L), axes=(1, 2))[:, 0, :S, :]
        y = y + kv * ssm_D[None, None, :]
        return q * y

    def _B_ref(x, w_gate, w_up, w_down):
        g = torch.einsum('bsd,df->bsf', x, w_gate)
        u = torch.einsum('bsd,df->bsf', x, w_up)
        h = g * u
        return torch.einsum('bsf,fd->bsd', h, w_down)
    x = A_q
    mod = (_silu(c) @ w_mod).reshape(c.shape[0], 6, 1, -1)
    sa, ca, ga, sb, cb, gb = (mod[:, 0].clone(), mod[:, 1].clone(), mod[:, 2].clone(), mod[:, 3].clone(), mod[:, 4].clone(), mod[:, 5].clone())
    h = _layernorm(x, axis=-1) * (1 + ca) + sa
    x = x + ga * _A_ref(h, A_k, A_v, A_shift_k, A_ssm_k, A_ssm_D)
    h = _layernorm(x, axis=-1) * (1 + cb) + sb
    x = x + gb * _B_ref(h, B_w_gate, B_w_up, B_w_down)
    return x
```

```asm
; @launch grid=(256,1,1) block=(256,1,1) lds=163840
.amdgcn_target "amdgcn-amd-amdhsa--gfx950"
.text
.globl adaLN_cond__ssm_conv_h3__glu_gated_bilinear__prompt_kernel
.p2align 8
.type adaLN_cond__ssm_conv_h3__glu_gated_bilinear__prompt_kernel,@function
adaLN_cond__ssm_conv_h3__glu_gated_bilinear__prompt_kernel:
    s_cmp_ge_u32 s2, 256
    s_cbranch_scc1 L_end
    s_load_dwordx16 s[16:31], s[0:1], 0
    s_load_dwordx8 s[32:39], s[0:1], 64
    s_load_dwordx2 s[40:41], s[0:1], 96
    s_load_dwordx2 s[44:45], s[0:1], 112
    s_getpc_b64 s[4:5]
L_pc0:
    s_lshl_b32 s6, s2, 3
    s_and_b32 s6, s6, 0xc0
    v_lshrrev_b32 v3, 2, v0
    v_add_lshl_u32 v3, v3, s6, 7
    v_min_u32 v3, L_codeend-L_pc0-4, v3
    global_load_dword v236, v3, s[4:5]
    v_lshrrev_b32 v1, 6, v0
    s_nop 0
    v_readfirstlane_b32 s3, v1
    v_and_b32 v1, 63, v0
    v_lshlrev_b32 v2, 4, v1
    s_and_b32 s46, s2, 7
    s_lshr_b32 s47, s2, 3
    s_mov_b32 s57, 0xffff0000
    s_mov_b32 s58, 0xfffffffe
    s_lshr_b32 s60, s47, 2
    s_lshl_b32 s61, s46, 3
    s_add_u32 s66, s60, s61
    s_and_b32 s61, s47, 3
    s_lshl_b32 s62, s66, 15
    s_lshl_b32 s63, s61, 8
    s_add_u32 s62, s62, s63
    s_lshl_b32 s63, s3, 6
    s_add_u32 s62, s62, s63
    v_and_b32 v5, 15, v1
    v_lshrrev_b32 v6, 4, v1
    v_lshlrev_b32 v7, 13, v6
    v_lshl_add_u32 v7, v5, 2, v7
    v_add_u32 v7, s62, v7
    v_subrev_u32 v3, 3072, v7
    v_add_u32 v4, 4096, v7
    s_lshl_b32 s63, s61, 2
    s_add_u32 s63, s63, s3
    s_lshl_b32 s63, s63, 4
    s_lshl_b32 s73, s63, 4
    v_lshlrev_b32 v8, 4, v5
    s_lshl2_add_u32 s65, s66, s61
    s_lshl_b32 s65, s65, 6
    s_lshl_b32 s69, s66, 8
    s_add_u32 s69, s69, s63
    s_lshl_b32 s69, s69, 7
    v_mov_b32 v244, -1
    v_mov_b32 v245, -1
    v_mov_b32 v246, -1
    v_mov_b32 v247, -1
    s_mul_i32 s67, s46, 6
    s_add_u32 s67, s67, s60
    s_lshl_b32 s67, s67, 2
    s_add_u32 s67, s67, s61
    s_cmp_ge_u32 s47, 24
    s_cselect_b32 s74, 1073741824, 0
    s_cmp_eq_u32 s3, 0
    s_cselect_b32 s70, 0, 1073741824
    s_lshl_b32 s42, s67, 6
    s_add_u32 s42, s42, 16777216
    s_or_b32 s63, s74, s70
    s_add_u32 s42, s42, s63
    s_lshr_b32 s63, s67, 5
    s_lshr_b32 s63, 0x12, s63
    s_and_b32 s63, s63, 1
    s_mul_i32 s43, s63, 0x3f800000
    s_lshl_b32 s63, s2, 6
    s_add_u32 s64, s63, s70
    s_add_u32 s70, s65, s70
    s_add_u32 s70, s70, 16973824
    v_lshrrev_b32 v9, 2, v1
    v_lshlrev_b32 v9, 14, v9
    v_and_b32 v40, 3, v1
    v_lshl_add_u32 v9, v40, 4, v9
    s_lshl_b32 s71, s3, 18
    s_lshl_b32 s72, s2, 6
    s_add_u32 s71, s71, s72
    s_add_u32 s71, s71, 2097152
    v_and_b32 v156, 1, v1
    s_waitcnt lgkmcnt(0)
    s_mov_b32 s4, s44
    s_mov_b32 s5, s45
    s_mov_b32 s6, 0x2000000
    s_mov_b32 s7, 0x20000
    s_add_u32 s62, s44, 17432576
    s_addc_u32 s63, s45, 0
    s_load_dword s56, s[62:63], 0
    buffer_store_dwordx4 v[244:247], v2, s[4:7], s69 offen sc1
    buffer_store_dwordx4 v[244:247], v2, s[4:7], s69 offen offset:1024 sc1
    buffer_store_dwordx4 v[244:247], v9, s[4:7], s71 offen sc1
    s_mov_b64 exec, 0xf
    buffer_store_dwordx4 v[244:247], v2, s[4:7], s42 offen sc1
    s_mov_b64 exec, -1
    s_mov_b32 s8, s18
    s_mov_b32 s9, s19
    s_mov_b32 s10, 0x200000
    s_mov_b32 s11, 0x20000
    s_mov_b32 s12, s20
    s_mov_b32 s13, s21
    s_mov_b32 s14, 0x200000
    s_mov_b32 s15, 0x20000
    buffer_load_dword v10, v3, s[8:11], 0 offen offset:0
    buffer_load_dword v11, v3, s[8:11], 0 offen offset:1024
    buffer_load_dword v12, v3, s[8:11], 0 offen offset:2048
    buffer_load_dword v13, v7, s[8:11], 0 offen offset:0
    buffer_load_dword v14, v7, s[8:11], 0 offen offset:1024
    buffer_load_dword v15, v7, s[8:11], 0 offen offset:2048
    buffer_load_dword v16, v7, s[8:11], 0 offen offset:3072
    buffer_load_dword v17, v4, s[8:11], 0 offen offset:0
    buffer_load_dword v18, v4, s[8:11], 0 offen offset:1024
    buffer_load_dword v19, v4, s[8:11], 0 offen offset:2048
    buffer_load_dword v20, v4, s[8:11], 0 offen offset:3072
    buffer_load_dword v21, v7, s[12:15], 0 offen offset:0
    buffer_load_dword v22, v7, s[12:15], 0 offen offset:1024
    buffer_load_dword v23, v7, s[12:15], 0 offen offset:2048
    buffer_load_dword v24, v7, s[12:15], 0 offen offset:3072
    buffer_load_dword v25, v4, s[12:15], 0 offen offset:0
    buffer_load_dword v26, v4, s[12:15], 0 offen offset:1024
    buffer_load_dword v27, v4, s[12:15], 0 offen offset:2048
    buffer_load_dword v28, v4, s[12:15], 0 offen offset:3072
    s_mov_b32 s52, s22
    s_mov_b32 s53, s23
    s_mov_b32 s54, 0x1000
    s_mov_b32 s55, 0x20000
    buffer_load_dwordx4 v[32:35], v8, s[52:55], s73 offen
    s_lshl_b32 s72, s2, 2
    s_load_dword s29, s[26:27], s72
    s_lshr_b32 s60, s3, 1
    s_and_b32 s61, s3, 1
    s_lshl1_add_u32 s62, s2, s60
    s_lshl_b32 s62, s62, 12
    s_load_dword s44, s[24:25], s62
    s_mov_b32 s52, s24
    s_mov_b32 s53, s25
    s_mov_b32 s54, 0x200000
    s_mov_b32 s55, 0x20000
    s_mul_i32 s65, s60, 8320
    s_lshl_b32 s63, s61, 11
    s_add_u32 s62, s62, s63
    s_add_u32 s63, s63, s65
    s_add_u32 m0, s63, 131104
    v_add_u32 v36, 2, v2
    buffer_load_dwordx4 v2, s[52:55], s62 offen lds
    buffer_load_dwordx4 v2, s[52:55], s62 offen offset:1024 lds
    s_add_u32 m0, s63, 135264
    s_lshl_b32 s61, s61, 8
    buffer_load_dwordx4 v36, s[52:55], s62 offen lds
    buffer_load_dwordx4 v36, s[52:55], s62 offen offset:1024 lds
    s_lshl_b32 s22, s46, 5
    s_add_u32 s22, s22, s47
    s_and_b32 s72, s46, 3
    s_mul_i32 s72, s72, 28
    s_add_u32 s72, s72, s47
    s_lshr_b32 s73, s46, 2
    s_lshl_b32 s73, s73, 3
    s_and_b32 s59, s72, 7
    s_lshl_b32 s26, s59, 12
    s_add_u32 s59, s59, s73
    s_lshr_b32 s66, s72, 3
    s_lshl2_add_u32 s28, s66, s3
    s_cmp_ge_u32 s47, 28
    s_cselect_b32 s75, 1073741824, 0
    s_cmp_ge_u32 s3, 2
    s_cselect_b32 s48, s32, s30
    s_cselect_b32 s49, s33, s31
    s_mov_b32 s50, 1835008
    s_mov_b32 s51, 0x20000
    s_lshl2_add_u32 s72, s22, s3
    s_lshl_b32 s68, s72, 10
    s_and_b32 s73, s3, 1
    s_mul_i32 s73, s73, 458752
    s_lshl_b32 s72, s66, 8
    s_add_u32 s73, s73, s72
    s_add_u32 s73, s73, s75
    s_lshl_b32 s19, s3, 15
    v_bfe_u32 v37, v1, 1, 3
    v_xor_b32 v38, v37, v6
    v_lshl_add_u32 v38, v38, 1, v156
    v_mul_u32_u24 v39, 3584, v6
    v_add_u32 v39, s73, v39
    v_lshl_add_u32 v240, v38, 4, v39
    v_add_u32 v241, 13312, v240
    v_xor_b32 v38, 8, v38
    v_lshl_add_u32 v242, v38, 4, v39
    v_add_u32 v242, 26624, v242
    v_add_u32 v243, 13312, v242
    v_lshrrev_b32 v4, 3, v1
    v_and_b32 v41, 7, v1
    s_mul_i32 s72, s60, 4608
    s_lshl_b32 s73, s61, 3
    s_add_u32 s72, s72, s73
    s_add_u32 s72, s72, 147712
    v_sub_u32 v128, 3, v6
    v_xor_b32 v128, v128, v41
    v_lshlrev_b32 v38, 7, v5
    v_lshl_add_u32 v128, v128, 4, v38
    v_add_u32 v128, s72, v128
    v_xor_b32 v157, 64, v128
    v_xor_b32 v129, v1, v4
    v_lshlrev_b32 v129, 4, v129
    v_add_u32 v129, s72, v129
    v_xor_b32 v130, 1, v156
    v_mul_u32_u24 v130, 4156, v130
    v_lshl_add_u32 v130, v37, 2, v130
    v_lshl_add_u32 v130, v6, 4, v130
    s_add_u32 s72, s65, s61
    s_add_u32 s72, s72, 131076
    v_add_u32 v130, s72, v130
    v_add_u32 v131, 1024, v130
    v_add_u32 v132, 2048, v130
    v_add_u32 v133, 3072, v130
    v_lshlrev_b32 v134, 15, v4
    v_lshl_add_u32 v134, v41, 4, v134
    s_lshl_b32 s30, s3, 19
    s_lshl_b32 s72, s2, 7
    s_add_u32 s30, s30, s72
    s_add_u32 s31, s30, 262144
    v_bfe_u32 v135, v1, 2, 1
    v_mul_u32_u24 v135, 4608, v135
    v_lshl_add_u32 v135, v40, 4, v135
    v_lshlrev_b32 v38, 6, v4
    v_sub_u32 v135, v135, v38
    s_lshl_b32 s72, s3, 10
    s_sub_u32 s73, 151232, s72
    v_add_u32 v135, s73, v135
    v_add_u32 v153, s72, v2
    s_add_u32 s72, s72, 131072
    v_xor_b32 v138, v1, v4
    v_lshlrev_b32 v138, 4, v138
    v_add_u32 v138, s72, v138
    v_lshlrev_b32 v136, 5, v5
    v_lshlrev_b32 v38, 4, v6
    v_sub_u32 v136, v38, v136
    s_mul_i32 s72, s60, 4608
    s_add_u32 s72, s72, s61
    s_add_u32 s72, s72, 148192
    v_add_u32 v136, s72, v136
    v_lshl_add_u32 v137, v5, 2, v6
    v_lshrrev_b32 v38, 3, v137
    v_xor_b32 v137, v137, v38
    v_lshlrev_b32 v137, 4, v137
    s_lshl_b32 s72, s3, 12
    s_add_u32 s72, s72, 131072
    v_add_u32 v137, s72, v137
    s_lshl_b32 s72, s3, 9
    s_sub_u32 s72, 149752, s72
    v_lshlrev_b32 v139, 3, v1
    v_sub_u32 v139, s72, v139
    v_bfe_u32 v141, v1, 2, 3
    s_lshl_b32 s63, s3, 1
    v_xor_b32 v141, s63, v141
    v_bfe_u32 v140, v1, 2, 2
    v_lshl_add_u32 v140, v6, 3, v140
    v_lshlrev_b32 v140, 8, v140
    v_and_b32 v142, 3, v1
    v_lshl_add_u32 v140, v142, 3, v140
    v_lshl_add_u32 v140, v141, 5, v140
    v_xor_b32 v141, 32, v140
    v_add_u32 v142, 0x10000, v140
    v_add_u32 v143, 0x10000, v141
    v_lshlrev_b32 v144, 3, v6
    v_lshl_add_u32 v144, v156, 5, v144
    s_lshl_b32 s72, s3, 6
    s_add_u32 s72, s72, 161024
    v_add_u32 v144, s72, v144
    v_lshlrev_b32 v146, 2, v5
    v_lshlrev_b32 v145, 3, v41
    v_add_u32 v145, 161024, v145
    v_min_u32 v38, 1, v6
    v_lshl_add_u32 v146, v38, 26, v146
    v_lshlrev_b32 v148, 6, v0
    v_lshrrev_b32 v150, 1, v1
    v_lshlrev_b32 v150, 6, v150
    v_lshl_add_u32 v150, v156, 4, v150
    v_lshlrev_b32 v151, 6, v0
    v_lshlrev_b32 v152, 2, v0
    s_lshr_b32 s32, s22, 2
    s_lshl_b32 s32, s32, 14
    s_and_b32 s72, s22, 3
    s_lshl_b32 s72, s72, 4
    s_add_u32 s32, s32, s72
    s_add_u32 s32, s32, 2097152
    v_mov_b32 v44, 0
    v_mov_b32 v45, 0
    v_mov_b32 v46, 0
    v_mov_b32 v47, 0
    v_lshrrev_b32 v38, 5, v1
    v_and_b32 v39, 31, v1
    v_mul_u32_u24 v38, 4608, v38
    v_lshl_add_u32 v38, v39, 4, v38
    v_add_u32 v38, 151808, v38
    ds_write_b128 v38, v[44:47]
    v_bfe_u32 v38, v1, 1, 1
    v_mul_u32_u24 v38, 4160, v38
    v_lshl_add_u32 v38, v156, 4, v38
    s_add_u32 s72, s65, 131072
    v_add_u32 v38, s72, v38
    s_waitcnt vmcnt(24)
    s_waitcnt lgkmcnt(0)
    s_mul_i32 s56, s56, 0x9e3779b1
    s_add_u32 s56, s56, 0x7f4a7c15
    v_mov_b32 v149, s56
    s_barrier
    buffer_store_dword v149, v146, s[4:7], s70 offen sc1
    s_mov_b32 s8, s38
    s_mov_b32 s9, s39
    s_mov_b32 s10, 0x300000
    s_mov_b32 s11, 0x20000
    s_mov_b32 s12, s36
    s_mov_b32 s13, s37
    s_mov_b32 s14, 0x400
    s_mov_b32 s15, 0x20000
    v_lshrrev_b32 v155, 1, v1
    v_mul_u32_u24 v154, 6144, v155
    v_lshl_add_u32 v154, v156, 4, v154
    s_lshl_b32 s73, s67, 5
    s_add_u32 s73, s73, s74
    v_add_u32 v154, s73, v154
    v_lshlrev_b32 v155, 1, v155
    s_add_u32 s72, s47, 0
    s_and_b32 s72, s72, 3
    s_lshl2_add_u32 s72, s3, s72
    s_lshl_b32 s73, s72, 6
    buffer_load_ushort v160, v155, s[12:15], s73 offen
    s_mul_i32 s72, s72, 196608
    buffer_load_dwordx4 v[164:167], v154, s[8:11], s72 offen
    s_waitcnt vmcnt(7)
    v_lshlrev_b32 v50, 16, v10
    v_and_b32 v51, s57, v10
    v_lshlrev_b32 v52, 16, v11
    v_and_b32 v53, s57, v11
    v_lshlrev_b32 v54, 16, v12
    v_and_b32 v55, s57, v12
    v_lshlrev_b32 v56, 16, v13
    v_and_b32 v57, s57, v13
    v_lshlrev_b32 v58, 16, v14
    v_and_b32 v59, s57, v14
    v_lshlrev_b32 v60, 16, v15
    v_and_b32 v61, s57, v15
    v_lshlrev_b32 v62, 16, v16
    v_and_b32 v63, s57, v16
    v_lshlrev_b32 v64, 16, v17
    v_and_b32 v65, s57, v17
    v_lshlrev_b32 v66, 16, v18
    v_and_b32 v67, s57, v18
    v_lshlrev_b32 v68, 16, v19
    v_and_b32 v69, s57, v19
    v_lshlrev_b32 v70, 16, v20
    v_and_b32 v71, s57, v20
    v_lshlrev_b32 v88, 16, v32
    v_lshlrev_b32 v89, 16, v34
    v_and_b32 v90, s57, v32
    v_and_b32 v91, s57, v34
    v_lshlrev_b32 v92, 16, v33
    v_lshlrev_b32 v93, 16, v35
    v_and_b32 v94, s57, v33
    v_and_b32 v95, s57, v35
    v_pk_mul_f32 v[96:97], v[50:51], v[94:95]
    v_pk_mul_f32 v[98:99], v[52:53], v[94:95]
    v_pk_mul_f32 v[100:101], v[54:55], v[94:95]
    v_pk_mul_f32 v[102:103], v[56:57], v[94:95]
    v_pk_mul_f32 v[104:105], v[58:59], v[94:95]
    v_pk_mul_f32 v[106:107], v[60:61], v[94:95]
    v_pk_mul_f32 v[108:109], v[62:63], v[94:95]
    v_pk_mul_f32 v[110:111], v[64:65], v[94:95]
    v_pk_fma_f32 v[96:97], v[52:53], v[92:93], v[96:97]
    v_pk_fma_f32 v[98:99], v[54:55], v[92:93], v[98:99]
    v_pk_fma_f32 v[100:101], v[56:57], v[92:93], v[100:101]
    v_pk_fma_f32 v[102:103], v[58:59], v[92:93], v[102:103]
    v_pk_fma_f32 v[104:105], v[60:61], v[92:93], v[104:105]
    v_pk_fma_f32 v[106:107], v[62:63], v[92:93], v[106:107]
    v_pk_fma_f32 v[108:109], v[64:65], v[92:93], v[108:109]
    v_pk_fma_f32 v[110:111], v[66:67], v[92:93], v[110:111]
    v_pk_fma_f32 v[96:97], v[54:55], v[90:91], v[96:97]
    v_pk_fma_f32 v[98:99], v[56:57], v[90:91], v[98:99]
    v_pk_fma_f32 v[100:101], v[58:59], v[90:91], v[100:101]
    v_pk_fma_f32 v[102:103], v[60:61], v[90:91], v[102:103]
    v_pk_fma_f32 v[104:105], v[62:63], v[90:91], v[104:105]
    v_pk_fma_f32 v[106:107], v[64:65], v[90:91], v[106:107]
    v_pk_fma_f32 v[108:109], v[66:67], v[90:91], v[108:109]
    v_pk_fma_f32 v[110:111], v[68:69], v[90:91], v[110:111]
    v_pk_fma_f32 v[96:97], v[56:57], v[88:89], v[96:97]
    v_pk_fma_f32 v[98:99], v[58:59], v[88:89], v[98:99]
    v_pk_fma_f32 v[100:101], v[60:61], v[88:89], v[100:101]
    v_pk_fma_f32 v[102:103], v[62:63], v[88:89], v[102:103]
    v_pk_fma_f32 v[104:105], v[64:65], v[88:89], v[104:105]
    v_pk_fma_f32 v[106:107], v[66:67], v[88:89], v[106:107]
    v_pk_fma_f32 v[108:109], v[68:69], v[88:89], v[108:109]
    v_pk_fma_f32 v[110:111], v[70:71], v[88:89], v[110:111]
    v_lshlrev_b32 v72, 16, v21
    v_and_b32 v73, s57, v21
    v_lshlrev_b32 v74, 16, v22
    v_and_b32 v75, s57, v22
    v_lshlrev_b32 v76, 16, v23
    v_and_b32 v77, s57, v23
    v_lshlrev_b32 v78, 16, v24
    v_and_b32 v79, s57, v24
    v_lshlrev_b32 v80, 16, v25
    v_and_b32 v81, s57, v25
    v_lshlrev_b32 v82, 16, v26
    v_and_b32 v83, s57, v26
    v_lshlrev_b32 v84, 16, v27
    v_and_b32 v85, s57, v27
    v_lshlrev_b32 v86, 16, v28
    v_and_b32 v87, s57, v28
    v_pk_mul_f32 v[96:97], v[96:97], v[72:73]
    v_pk_mul_f32 v[98:99], v[98:99], v[74:75]
    v_pk_mul_f32 v[100:101], v[100:101], v[76:77]
    v_pk_mul_f32 v[102:103], v[102:103], v[78:79]
    v_pk_mul_f32 v[104:105], v[104:105], v[80:81]
    v_pk_mul_f32 v[106:107], v[106:107], v[82:83]
    v_pk_mul_f32 v[108:109], v[108:109], v[84:85]
    v_pk_mul_f32 v[110:111], v[110:111], v[86:87]
    v_cvt_pk_bf16_f32 v112, v110, v108
    v_cvt_pk_bf16_f32 v113, v106, v104
    v_cvt_pk_bf16_f32 v114, v102, v100
    v_cvt_pk_bf16_f32 v115, v98, v96
    v_min_u32 v112, s58, v112
    v_min_u32 v113, s58, v113
    v_min_u32 v114, s58, v114
    v_min_u32 v115, s58, v115
    ds_write_b128 v128, v[112:115]
    v_cvt_pk_bf16_f32 v116, v111, v109
    v_cvt_pk_bf16_f32 v117, v107, v105
    v_cvt_pk_bf16_f32 v118, v103, v101
    v_cvt_pk_bf16_f32 v119, v99, v97
    v_min_u32 v116, s58, v116
    v_min_u32 v117, s58, v117
    v_min_u32 v118, s58, v118
    v_min_u32 v119, s58, v119
    ds_write_b128 v157, v[116:119]
    ds_read_b128 v[112:115], v129
    ds_read_b128 v[116:119], v129 offset:1024
    s_waitcnt lgkmcnt(1)
    buffer_store_dwordx4 v[112:115], v2, s[4:7], s69 offen sc1
    s_waitcnt lgkmcnt(0)
    buffer_store_dwordx4 v[116:119], v2, s[4:7], s69 offen offset:1024 sc1
    v_bfe_u32 v158, v1, 3, 2
    v_mul_u32_u24 v158, 3584, v158
    v_and_b32 v147, 7, v1
    v_lshl_add_u32 v158, v147, 7, v158
    s_and_b32 s73, s3, 1
    s_lshl1_add_u32 s72, s47, s73
    s_mul_i32 s72, s72, 14336
    s_and_b32 s73, s46, 3
    s_mul_i32 s73, s73, 28
    s_lshr_b32 s73, s73, 3
    s_lshl_b32 s73, s73, 8
    s_add_u32 s72, s72, s73
    buffer_load_dword v159, v158, s[48:51], s72 offen
    v_cmp_eq_u32 vcc, 3, v40
    s_waitcnt vmcnt(6)
    s_lshl_b32 s44, s44, 16
    v_mov_b32 v31, s44
    v_cndmask_b32 v47, v47, v31, vcc
    s_mov_b64 exec, 0xf
    ds_write_b128 v38, v[44:47]
    s_mov_b64 exec, -1
    s_lshl_b32 s44, s29, 16
    s_and_b32 s45, s29, s57
    s_barrier
    ds_read2_b32 a[128:129], v130 offset0:0 offset1:1
    ds_read2_b32 a[130:131], v130 offset0:2 offset1:3
    ds_read2_b32 a[132:133], v130 offset0:128 offset1:129
    ds_read2_b32 a[134:135], v130 offset0:130 offset1:131
    ds_read2_b32 a[136:137], v131 offset0:0 offset1:1
    ds_read2_b32 a[138:139], v131 offset0:2 offset1:3
    ds_read2_b32 a[140:141], v131 offset0:128 offset1:129
    ds_read2_b32 a[142:143], v131 offset0:130 offset1:131
    ds_read2_b32 a[144:145], v132 offset0:0 offset1:1
    ds_read2_b32 a[146:147], v132 offset0:2 offset1:3
    ds_read2_b32 a[148:149], v132 offset0:128 offset1:129
    ds_read2_b32 a[150:151], v132 offset0:130 offset1:131
    ds_read2_b32 a[152:153], v133 offset0:0 offset1:1
    ds_read2_b32 a[154:155], v133 offset0:2 offset1:3
    ds_read2_b32 a[156:157], v133 offset0:128 offset1:129
    ds_read2_b32 a[158:159], v133 offset0:130 offset1:131
    ds_read2_b32 a[160:161], v130 offset0:16 offset1:17
    ds_read2_b32 a[162:163], v130 offset0:18 offset1:19
    ds_read2_b32 a[164:165], v130 offset0:144 offset1:145
    ds_read2_b32 a[166:167], v130 offset0:146 offset1:147
    ds_read2_b32 a[168:169], v131 offset0:16 offset1:17
    ds_read2_b32 a[170:171], v131 offset0:18 offset1:19
    ds_read2_b32 a[172:173], v131 offset0:144 offset1:145
    ds_read2_b32 a[174:175], v131 offset0:146 offset1:147
    ds_read2_b32 a[176:177], v132 offset0:16 offset1:17
    ds_read2_b32 a[178:179], v132 offset0:18 offset1:19
    ds_read2_b32 a[180:181], v132 offset0:144 offset1:145
    ds_read2_b32 a[182:183], v132 offset0:146 offset1:147
    ds_read2_b32 a[184:185], v133 offset0:16 offset1:17
    ds_read2_b32 a[186:187], v133 offset0:18 offset1:19
    s_mov_b32 s62, 16973824
    buffer_load_dword v239, v148, s[4:7], s62 offen sc1
    ds_read2_b32 a[188:189], v133 offset0:144 offset1:145
    ds_read2_b32 a[190:191], v133 offset0:146 offset1:147
    ds_read2_b32 a[192:193], v130 offset0:32 offset1:33
    ds_read2_b32 a[194:195], v130 offset0:34 offset1:35
    ds_read2_b32 a[196:197], v130 offset0:160 offset1:161
    ds_read2_b32 a[198:199], v130 offset0:162 offset1:163
    ds_read2_b32 a[200:201], v131 offset0:32 offset1:33
    ds_read2_b32 a[202:203], v131 offset0:34 offset1:35
    ds_read2_b32 a[204:205], v131 offset0:160 offset1:161
    ds_read2_b32 a[206:207], v131 offset0:162 offset1:163
    ds_read2_b32 a[208:209], v132 offset0:32 offset1:33
    ds_read2_b32 a[210:211], v132 offset0:34 offset1:35
    ds_read2_b32 a[212:213], v132 offset0:160 offset1:161
    ds_read2_b32 a[214:215], v132 offset0:162 offset1:163
    ds_read2_b32 a[216:217], v133 offset0:32 offset1:33
    ds_read2_b32 a[218:219], v133 offset0:34 offset1:35
    ds_read2_b32 a[220:221], v133 offset0:160 offset1:161
    ds_read2_b32 a[222:223], v133 offset0:162 offset1:163
    s_add_u32 s72, s47, 1
    s_and_b32 s72, s72, 3
    s_lshl2_add_u32 s72, s3, s72
    s_lshl_b32 s73, s72, 6
    buffer_load_ushort v161, v155, s[12:15], s73 offen
    s_mul_i32 s72, s72, 196608
    buffer_load_dwordx4 v[168:171], v154, s[8:11], s72 offen
    s_add_u32 s72, s47, 2
    s_and_b32 s72, s72, 3
    s_lshl2_add_u32 s72, s3, s72
    s_lshl_b32 s73, s72, 6
    buffer_load_ushort v162, v155, s[12:15], s73 offen
    s_mul_i32 s72, s72, 196608
    buffer_load_dwordx4 v[172:175], v154, s[8:11], s72 offen
    s_add_u32 s72, s47, 3
    s_and_b32 s72, s72, 3
    s_lshl2_add_u32 s72, s3, s72
    s_lshl_b32 s73, s72, 6
    buffer_load_ushort v163, v155, s[12:15], s73 offen
    s_mul_i32 s72, s72, 196608
    buffer_load_dwordx4 v[176:179], v154, s[8:11], s72 offen
    ds_read2_b32 a[224:225], v130 offset0:48 offset1:49
    ds_read2_b32 a[226:227], v130 offset0:50 offset1:51
    ds_read2_b32 a[228:229], v130 offset0:176 offset1:177
    ds_read2_b32 a[230:231], v130 offset0:178 offset1:179
    ds_read2_b32 a[232:233], v131 offset0:48 offset1:49
    ds_read2_b32 a[234:235], v131 offset0:50 offset1:51
    ds_read2_b32 a[236:237], v131 offset0:176 offset1:177
    ds_read2_b32 a[238:239], v131 offset0:178 offset1:179
    ds_read2_b32 a[240:241], v132 offset0:48 offset1:49
    ds_read2_b32 a[242:243], v132 offset0:50 offset1:51
    ds_read2_b32 a[244:245], v132 offset0:176 offset1:177
    ds_read2_b32 a[246:247], v132 offset0:178 offset1:179
    ds_read2_b32 a[248:249], v133 offset0:48 offset1:49
    ds_read2_b32 a[250:251], v133 offset0:50 offset1:51
    ds_read2_b32 a[252:253], v133 offset0:176 offset1:177
    ds_read2_b32 a[254:255], v133 offset0:178 offset1:179
    s_waitcnt vmcnt(6)
    v_cmp_ne_u32 vcc, s56, v239
    s_nop 0
    s_cbranch_vccnz L_slow1
L_back1:
    buffer_load_dwordx4 v[16:19], v134, s[4:7], s30 offen sc1
    buffer_load_dwordx4 v[20:23], v134, s[4:7], s31 offen sc1
    s_waitcnt vmcnt(2)
    v_lshlrev_b32 v160, 16, v160
    v_mul_f32 v236, 0xbfb8aa3b, v160
    v_lshlrev_b32 v161, 16, v161
    v_mul_f32 v237, 0xbfb8aa3b, v161
    v_lshlrev_b32 v162, 16, v162
    v_mul_f32 v238, 0xbfb8aa3b, v162
    v_lshlrev_b32 v163, 16, v163
    v_mul_f32 v239, 0xbfb8aa3b, v163
    v_exp_f32 v236, v236
    v_exp_f32 v237, v237
    v_exp_f32 v238, v238
    v_exp_f32 v239, v239
    v_add_f32 v236, 1.0, v236
    v_add_f32 v237, 1.0, v237
    v_add_f32 v238, 1.0, v238
    v_add_f32 v239, 1.0, v239
    v_rcp_f32 v236, v236
    v_rcp_f32 v237, v237
    v_rcp_f32 v238, v238
    v_rcp_f32 v239, v239
    v_mul_f32 v160, v160, v236
    v_mul_f32 v161, v161, v237
    v_mul_f32 v162, v162, v238
    v_mul_f32 v163, v163, v239
    v_cvt_pk_bf16_f32 v236, v160, v160
    v_cvt_pk_bf16_f32 v237, v161, v161
    v_cvt_pk_bf16_f32 v238, v162, v162
    v_cvt_pk_bf16_f32 v239, v163, v163
    v_lshlrev_b32 v212, 16, v236
    v_lshlrev_b32 v214, 16, v237
    v_lshlrev_b32 v216, 16, v238
    v_lshlrev_b32 v218, 16, v239
    v_lshlrev_b32 v220, 16, v164
    v_and_b32 v221, s57, v164
    v_lshlrev_b32 v222, 16, v165
    v_and_b32 v223, s57, v165
    v_lshlrev_b32 v224, 16, v166
    v_and_b32 v225, s57, v166
    v_lshlrev_b32 v226, 16, v167
    v_and_b32 v227, s57, v167
    v_pk_mul_f32 v[228:229], v[220:221], v[212:213] op_sel_hi:[1,0]
    v_pk_mul_f32 v[230:231], v[222:223], v[212:213] op_sel_hi:[1,0]
    v_pk_mul_f32 v[232:233], v[224:225], v[212:213] op_sel_hi:[1,0]
    v_pk_mul_f32 v[234:235], v[226:227], v[212:213] op_sel_hi:[1,0]
    v_lshlrev_b32 v220, 16, v168
    v_and_b32 v221, s57, v168
    v_lshlrev_b32 v222, 16, v169
    v_and_b32 v223, s57, v169
    v_lshlrev_b32 v224, 16, v170
    v_and_b32 v225, s57, v170
    v_lshlrev_b32 v226, 16, v171
    v_and_b32 v227, s57, v171
    v_pk_fma_f32 v[228:229], v[220:221], v[214:215], v[228:229] op_sel_hi:[1,0,1]
    v_pk_fma_f32 v[230:231], v[222:223], v[214:215], v[230:231] op_sel_hi:[1,0,1]
    v_pk_fma_f32 v[232:233], v[224:225], v[214:215], v[232:233] op_sel_hi:[1,0,1]
    v_pk_fma_f32 v[234:235], v[226:227], v[214:215], v[234:235] op_sel_hi:[1,0,1]
    v_lshlrev_b32 v220, 16, v172
    v_and_b32 v221, s57, v172
    v_lshlrev_b32 v222, 16, v173
    v_and_b32 v223, s57, v173
    v_lshlrev_b32 v224, 16, v174
    v_and_b32 v225, s57, v174
    v_lshlrev_b32 v226, 16, v175
    v_and_b32 v227, s57, v175
    v_pk_fma_f32 v[228:229], v[220:221], v[216:217], v[228:229] op_sel_hi:[1,0,1]
    v_pk_fma_f32 v[230:231], v[222:223], v[216:217], v[230:231] op_sel_hi:[1,0,1]
    v_pk_fma_f32 v[232:233], v[224:225], v[216:217], v[232:233] op_sel_hi:[1,0,1]
    v_pk_fma_f32 v[234:235], v[226:227], v[216:217], v[234:235] op_sel_hi:[1,0,1]
    v_lshlrev_b32 v220, 16, v176
    v_and_b32 v221, s57, v176
    v_lshlrev_b32 v222, 16, v177
    v_and_b32 v223, s57, v177
    v_lshlrev_b32 v224, 16, v178
    v_and_b32 v225, s57, v178
    v_lshlrev_b32 v226, 16, v179
    v_and_b32 v227, s57, v179
    v_pk_fma_f32 v[228:229], v[220:221], v[218:219], v[228:229] op_sel_hi:[1,0,1]
    v_pk_fma_f32 v[230:231], v[222:223], v[218:219], v[230:231] op_sel_hi:[1,0,1]
    v_pk_fma_f32 v[232:233], v[224:225], v[218:219], v[232:233] op_sel_hi:[1,0,1]
    v_pk_fma_f32 v[234:235], v[226:227], v[218:219], v[234:235] op_sel_hi:[1,0,1]
    s_nop 0
    v_permlane32_swap_b32 v228, v232
    v_permlane32_swap_b32 v229, v233
    v_permlane32_swap_b32 v230, v234
    v_permlane32_swap_b32 v231, v235
    v_add_f32 v228, v228, v232
    v_add_f32 v229, v229, v233
    v_add_f32 v230, v230, v234
    v_add_f32 v231, v231, v235
    s_nop 0
    v_permlane16_swap_b32 v228, v230
    v_permlane16_swap_b32 v229, v231
    v_add_f32 v228, v228, v230
    v_add_f32 v229, v229, v231
    s_nop 0
    v_add_f32_dpp v228, v228, v228 row_ror:8 row_mask:0xf bank_mask:0xf
    v_add_f32_dpp v229, v229, v229 row_ror:8 row_mask:0xf bank_mask:0xf
    s_nop 0
    v_add_f32_dpp v228, v228, v228 row_ror:4 row_mask:0xf bank_mask:0xf
    v_add_f32_dpp v229, v229, v229 row_ror:4 row_mask:0xf bank_mask:0xf
    s_nop 0
    v_add_f32_dpp v228, v228, v228 row_ror:2 row_mask:0xf bank_mask:0xf
    v_add_f32_dpp v229, v229, v229 row_ror:2 row_mask:0xf bank_mask:0xf
    ds_write_b64 v144, v[228:229]
    s_waitcnt vmcnt(0)
    v_max3_u32 v29, v16, v17, v18
    v_max3_u32 v29, v29, v19, v20
    v_max3_u32 v29, v29, v21, v22
    v_max_u32 v29, v29, v23
    v_cmp_eq_u32 vcc, -1, v29
    s_nop 0
    s_cbranch_vccnz L_slow2
L_back2:
    ds_write_b128 v135, v[16:19] offset:512
    ds_write_b128 v135, v[20:23]
    s_waitcnt lgkmcnt(0)
    s_barrier
    ds_read_b128 v[64:67], v136 offset:3584
    ds_read_b128 v[68:71], v136 offset:3072
    ds_read_b128 v[72:75], v136 offset:2560
    ds_read_b128 v[76:79], v136 offset:2048
    s_waitcnt lgkmcnt(3)
    v_mfma_f32_16x16x32_bf16 v[32:35], a[128:131], v[64:67], 0
    s_add_u32 s72, s71, 1048576
    ds_read_b128 v[96:99], v136 offset:3648
    v_mfma_f32_16x16x32_bf16 v[36:39], a[132:135], v[64:67], 0
    ds_read2_b64 v[192:195], v145 offset0:0 offset1:8
    v_mfma_f32_16x16x32_bf16 v[40:43], a[136:139], v[64:67], 0
    ds_read2_b64 v[196:199], v145 offset0:16 offset1:24
    v_mfma_f32_16x16x32_bf16 v[44:47], a[140:143], v[64:67], 0
    s_waitcnt lgkmcnt(5)
    buffer_store_dwordx4 v[244:247], v9, s[4:7], s72 offen sc1
    s_add_u32 s72, s68, 4194304
    v_mfma_f32_16x16x32_bf16 v[36:39], a[128:131], v[68:71], v[36:39]
    ds_read_b128 v[100:103], v136 offset:3136
    v_mfma_f32_16x16x32_bf16 v[40:43], a[132:135], v[68:71], v[40:43]
    buffer_store_dwordx4 v[244:247], v2, s[4:7], s72 offen sc1
    s_add_u32 s72, s68, 5242880
    v_mfma_f32_16x16x32_bf16 v[44:47], a[136:139], v[68:71], v[44:47]
    s_waitcnt lgkmcnt(5)
    s_waitcnt lgkmcnt(1)
    v_add_f32 v192, v192, v194
    v_mfma_f32_16x16x32_bf16 v[40:43], a[128:131], v[72:75], v[40:43]
    ds_read_b128 v[104:107], v136 offset:2624
    v_add_f32 v193, v193, v195
    v_mfma_f32_16x16x32_bf16 v[44:47], a[132:135], v[72:75], v[44:47]
    s_waitcnt lgkmcnt(5)
    buffer_store_dwordx4 v[244:247], v2, s[4:7], s72 offen sc1
    v_add_f32 v196, v196, v198
    v_mfma_f32_16x16x32_bf16 v[44:47], a[128:131], v[76:79], v[44:47]
    s_waitcnt lgkmcnt(4)
    ds_read_b128 v[108:111], v136 offset:2112
    v_add_f32 v197, v197, v199
    v_mfma_f32_16x16x32_bf16 v[32:35], a[160:163], v[96:99], v[32:35]
    s_mov_b32 s52, s16
    ds_read_b128 v[64:67], v136 offset:3712
    v_add_f32 v192, v192, v196
    v_mfma_f32_16x16x32_bf16 v[36:39], a[164:167], v[96:99], v[36:39]
    s_mov_b32 s53, s17
    v_add_f32 v193, v193, v197
    v_cvt_pk_bf16_f32 v20, v192, v193
    v_mfma_f32_16x16x32_bf16 v[40:43], a[168:171], v[96:99], v[40:43]
    s_mov_b32 s54, 0x200000
    v_lshlrev_b32 v192, 16, v20
    v_and_b32 v193, s57, v20
    v_mfma_f32_16x16x32_bf16 v[44:47], a[172:175], v[96:99], v[44:47]
    s_waitcnt lgkmcnt(3)
    v_add_f32 v192, s43, v192
    v_add_f32 v193, s43, v193
    v_mfma_f32_16x16x32_bf16 v[36:39], a[160:163], v[100:103], v[36:39]
    s_mov_b32 s55, 0x20000
    ds_read_b128 v[68:71], v136 offset:3200
    v_cvt_pk_bf16_f32 v20, v192, v193
    v_mfma_f32_16x16x32_bf16 v[40:43], a[164:167], v[100:103], v[40:43]
    s_add_u32 s73, s68, 0x100000
    buffer_load_dwordx4 v[180:183], v2, s[52:55], s68 offen
    v_min_u32 v20, s58, v20
    v_mfma_f32_16x16x32_bf16 v[44:47], a[168:171], v[100:103], v[44:47]
    s_waitcnt lgkmcnt(3)
    buffer_store_dword v20, v146, s[4:7], s42 offen sc1
    v_mfma_f32_16x16x32_bf16 v[40:43], a[160:163], v[104:107], v[40:43]
    ds_read_b128 v[72:75], v136 offset:2688
    v_mfma_f32_16x16x32_bf16 v[44:47], a[164:167], v[104:107], v[44:47]
    s_waitcnt lgkmcnt(3)
    ds_read_b64 v[10:11], v139 offset:2048
    v_mfma_f32_16x16x32_bf16 v[44:47], a[160:163], v[108:111], v[44:47]
    s_waitcnt lgkmcnt(3)
    ds_read_b128 v[76:79], v136 offset:2176
    v_mfma_f32_16x16x32_bf16 v[32:35], a[192:195], v[64:67], v[32:35]
    ds_read_b128 v[96:99], v136 offset:3776
    v_mfma_f32_16x16x32_bf16 v[36:39], a[196:199], v[64:67], v[36:39]
    ds_read_b64 v[12:13], v139 offset:6656
    v_mfma_f32_16x16x32_bf16 v[40:43], a[200:203], v[64:67], v[40:43]
    ds_read_b64 v[14:15], v139 offset:0
    v_mfma_f32_16x16x32_bf16 v[44:47], a[204:207], v[64:67], v[44:47]
    s_waitcnt lgkmcnt(6)
    ds_read_b64 v[16:17], v139 offset:4608
    s_min_u32 s60, s64, 1
    v_mfma_f32_16x16x32_bf16 v[36:39], a[192:195], v[68:71], v[36:39]
    s_lshl_b32 s60, s60, 30
    ds_read_b128 v[100:103], v136 offset:3264
    s_add_u32 s60, s60, 17432576
    v_mfma_f32_16x16x32_bf16 v[40:43], a[196:199], v[68:71], v[40:43]
    buffer_store_dword v149, v146, s[4:7], s60 offen sc1
    s_waitcnt lgkmcnt(1)
    v_mfma_f32_16x16x32_bf16 v[44:47], a[200:203], v[68:71], v[44:47]
    s_waitcnt lgkmcnt(7)
    buffer_load_dwordx4 v[184:187], v2, s[52:55], s73 offen
    v_and_b32 v24, s57, v11
    v_mfma_f32_16x16x32_bf16 v[40:43], a[192:195], v[72:75], v[40:43]
    s_add_u32 m0, s19, 0
    ds_read_b128 v[104:107], v136 offset:2752
    v_lshlrev_b32 v25, 16, v11
    v_mfma_f32_16x16x32_bf16 v[44:47], a[196:199], v[72:75], v[44:47]
    s_waitcnt lgkmcnt(6)
    v_and_b32 v26, s57, v10
    v_lshlrev_b32 v27, 16, v10
    v_mfma_f32_16x16x32_bf16 v[44:47], a[192:195], v[76:79], v[44:47]
    s_waitcnt lgkmcnt(5)
    ds_read_b128 v[108:111], v136 offset:2240
    v_and_b32 v28, s57, v13
    v_mfma_f32_16x16x32_bf16 v[32:35], a[224:227], v[96:99], v[32:35]
    s_mov_b32 s27, 0
    ds_read_b128 v[64:67], v136 offset:3584
    v_lshlrev_b32 v29, 16, v13
    v_mfma_f32_16x16x32_bf16 v[36:39], a[228:231], v[96:99], v[36:39]
    s_waitcnt lgkmcnt(3)
    ds_read_b128 v[80:83], v136 offset:1536
    v_and_b32 v30, s57, v12
    v_mfma_f32_16x16x32_bf16 v[36:39], a[224:227], v[100:103], v[36:39]
    ds_read_b128 v[68:71], v136 offset:3072
    v_lshlrev_b32 v31, 16, v12
    v_mfma_f32_16x16x32_bf16 v[40:43], a[232:235], v[96:99], v[40:43]
    ds_read_b128 v[84:87], v136 offset:1024
    v_mfma_f32_16x16x32_bf16 v[40:43], a[228:231], v[100:103], v[40:43]
    s_waitcnt lgkmcnt(5)
    ds_write_b128 v137, v[32:35] offset:0
    v_and_b32 v168, s57, v15
    v_mfma_f32_16x16x32_bf16 v[40:43], a[224:227], v[104:107], v[40:43]
    ds_read_b128 v[72:75], v136 offset:2560
    v_mfma_f32_16x16x32_bf16 v[44:47], a[236:239], v[96:99], v[44:47]
    ds_read_b128 v[88:91], v136 offset:512
    v_mfma_f32_16x16x32_bf16 v[44:47], a[232:235], v[100:103], v[44:47]
    ds_write_b128 v137, v[36:39] offset:1024
    v_lshlrev_b32 v169, 16, v15
    v_mfma_f32_16x16x32_bf16 v[44:47], a[228:231], v[104:107], v[44:47]
    s_waitcnt lgkmcnt(8)
    ds_write_b128 v137, v[40:43] offset:2048
    v_and_b32 v170, s57, v14
    v_mfma_f32_16x16x32_bf16 v[44:47], a[224:227], v[108:111], v[44:47]
    s_waitcnt lgkmcnt(8)
    ds_read_b128 v[76:79], v136 offset:2048
    v_lshlrev_b32 v171, 16, v14
    v_mfma_f32_16x16x32_bf16 v[48:51], a[144:147], v[64:67], 0
    ds_read_b128 v[92:95], v136 offset:0
    v_and_b32 v172, s57, v17
    v_mfma_f32_16x16x32_bf16 v[52:55], a[148:151], v[64:67], 0
    ds_read_b128 v[96:99], v136 offset:3648
    v_lshlrev_b32 v173, 16, v17
    v_mfma_f32_16x16x32_bf16 v[56:59], a[152:155], v[64:67], 0
    buffer_load_dwordx4 v240, s[48:51], s27 offen offset:0 lds
    v_and_b32 v174, s57, v16
    v_mfma_f32_16x16x32_bf16 v[60:63], a[156:159], v[64:67], 0
    s_waitcnt lgkmcnt(9)
    v_lshlrev_b32 v175, 16, v16
    v_mfma_f32_16x16x32_bf16 v[48:51], a[140:143], v[68:71], v[48:51]
    ds_read_b128 v[100:103], v136 offset:3136
    v_mfma_f32_16x16x32_bf16 v[52:55], a[144:147], v[68:71], v[52:55]
    ds_write_b128 v137, v[44:47] offset:3072
    v_mfma_f32_16x16x32_bf16 v[56:59], a[148:151], v[68:71], v[56:59]
    buffer_load_dwordx4 v241, s[48:51], s27 offen offset:1024 lds
    v_mfma_f32_16x16x32_bf16 v[60:63], a[152:155], v[68:71], v[60:63]
    s_waitcnt lgkmcnt(8)
    v_mfma_f32_16x16x32_bf16 v[48:51], a[136:139], v[72:75], v[48:51]
    ds_read_b128 v[104:107], v136 offset:2624
    v_mfma_f32_16x16x32_bf16 v[52:55], a[140:143], v[72:75], v[52:55]
    s_waitcnt vmcnt(6) lgkmcnt(1)
    buffer_load_dwordx4 v242, s[48:51], s27 offen offset:2048 lds
    v_mfma_f32_16x16x32_bf16 v[56:59], a[144:147], v[72:75], v[56:59]
    s_barrier
    v_mfma_f32_16x16x32_bf16 v[60:63], a[148:151], v[72:75], v[60:63]
    s_waitcnt lgkmcnt(5)
    ds_read_b128 v[192:195], v138 offset:0
    v_mfma_f32_16x16x32_bf16 v[48:51], a[132:135], v[76:79], v[48:51]
    ds_read_b128 v[108:111], v136 offset:2112
    v_mfma_f32_16x16x32_bf16 v[52:55], a[136:139], v[76:79], v[52:55]
    ds_read_b128 v[196:199], v138 offset:4096
    v_mfma_f32_16x16x32_bf16 v[56:59], a[140:143], v[76:79], v[56:59]
    ds_read_b128 v[200:203], v138 offset:8192
    v_mfma_f32_16x16x32_bf16 v[60:63], a[144:147], v[76:79], v[60:63]
    s_waitcnt lgkmcnt(15)
    ds_read_b128 v[204:207], v138 offset:12288
    s_add_u32 s60, s64, 17039360
    v_mfma_f32_16x16x32_bf16 v[48:51], a[128:131], v[80:83], v[48:51]
    ds_read_b128 v[112:115], v136 offset:1600
    v_mfma_f32_16x16x32_bf16 v[52:55], a[132:135], v[80:83], v[52:55]
    buffer_store_dword v149, v146, s[4:7], s60 offen sc1
    v_mfma_f32_16x16x32_bf16 v[56:59], a[136:139], v[80:83], v[56:59]
    buffer_load_dwordx4 v243, s[48:51], s27 offen offset:3072 lds
    s_add_u32 m0, s19, 4096
    v_mfma_f32_16x16x32_bf16 v[60:63], a[140:143], v[80:83], v[60:63]
    s_waitcnt lgkmcnt(15)
    s_mov_b32 s27, 57344
    v_mfma_f32_16x16x32_bf16 v[52:55], a[128:131], v[84:87], v[52:55]
    s_waitcnt lgkmcnt(1)
    ds_read_b128 v[116:119], v136 offset:1088
    v_add_f32 v192, v192, v196
    v_mfma_f32_16x16x32_bf16 v[56:59], a[132:135], v[84:87], v[56:59]
    buffer_load_dwordx4 v240, s[48:51], s27 offen offset:0 lds
    v_add_f32 v193, v193, v197
    v_mfma_f32_16x16x32_bf16 v[60:63], a[136:139], v[84:87], v[60:63]
    s_waitcnt lgkmcnt(15)
    v_add_f32 v194, v194, v198
    v_add_f32 v195, v195, v199
    v_mfma_f32_16x16x32_bf16 v[56:59], a[128:131], v[88:91], v[56:59]
    ds_read_b128 v[120:123], v136 offset:576
    v_fmac_f32 v192, s44, v24
    v_mfma_f32_16x16x32_bf16 v[60:63], a[132:135], v[88:91], v[60:63]
    s_waitcnt lgkmcnt(12)
    buffer_load_dwordx4 v241, s[48:51], s27 offen offset:1024 lds
    v_fmac_f32 v193, s44, v25
    v_mfma_f32_16x16x32_bf16 v[60:63], a[128:131], v[92:95], v[60:63]
    s_waitcnt lgkmcnt(11)
    ds_read_b128 v[124:127], v136 offset:64
    v_fmac_f32 v194, s44, v26
    v_mfma_f32_16x16x32_bf16 v[48:51], a[176:179], v[96:99], v[48:51]
    ds_read_b128 v[64:67], v136 offset:3712
    v_fmac_f32 v195, s44, v27
    v_mfma_f32_16x16x32_bf16 v[52:55], a[180:183], v[96:99], v[52:55]
    buffer_load_dwordx4 v242, s[48:51], s27 offen offset:2048 lds
    v_add_f32 v200, v200, v204
    v_mfma_f32_16x16x32_bf16 v[56:59], a[184:187], v[96:99], v[56:59]
    v_add_f32 v201, v201, v205
    v_add_f32 v202, v202, v206
    v_mfma_f32_16x16x32_bf16 v[60:63], a[188:191], v[96:99], v[60:63]
    s_waitcnt lgkmcnt(12)
    buffer_load_dwordx4 v243, s[48:51], s27 offen offset:3072 lds
    v_add_f32 v203, v203, v207
    v_mfma_f32_16x16x32_bf16 v[48:51], a[172:175], v[100:103], v[48:51]
    s_add_u32 m0, s19, 8192
    ds_read_b128 v[68:71], v136 offset:3200
    v_fmac_f32 v200, s45, v28
    v_mfma_f32_16x16x32_bf16 v[52:55], a[176:179], v[100:103], v[52:55]
    s_mov_b32 s27, 114688
    buffer_load_dwordx4 v240, s[48:51], s27 offen offset:0 lds
    v_fmac_f32 v201, s45, v29
    v_mfma_f32_16x16x32_bf16 v[56:59], a[180:183], v[100:103], v[56:59]
    v_fmac_f32 v202, s45, v30
    v_fmac_f32 v203, s45, v31
    v_mfma_f32_16x16x32_bf16 v[60:63], a[184:187], v[100:103], v[60:63]
    s_waitcnt lgkmcnt(11)
    buffer_load_dwordx4 v241, s[48:51], s27 offen offset:1024 lds
    v_cvt_pk_bf16_f32 v208, v192, v200
    v_mfma_f32_16x16x32_bf16 v[48:51], a[168:171], v[104:107], v[48:51]
    ds_read_b128 v[72:75], v136 offset:2688
    v_cvt_pk_bf16_f32 v209, v193, v201
    v_mfma_f32_16x16x32_bf16 v[52:55], a[172:175], v[104:107], v[52:55]
    buffer_load_dwordx4 v242, s[48:51], s27 offen offset:2048 lds
    v_cvt_pk_bf16_f32 v210, v194, v202
    v_mfma_f32_16x16x32_bf16 v[56:59], a[176:179], v[104:107], v[56:59]
    v_cvt_pk_bf16_f32 v211, v195, v203
    v_min_u32 v208, s58, v208
    v_mfma_f32_16x16x32_bf16 v[60:63], a[180:183], v[104:107], v[60:63]
    s_waitcnt lgkmcnt(10)
    buffer_load_dwordx4 v243, s[48:51], s27 offen offset:3072 lds
    v_min_u32 v209, s58, v209
    v_mfma_f32_16x16x32_bf16 v[48:51], a[164:167], v[108:111], v[48:51]
    s_add_u32 m0, s19, 12288
    ds_read_b128 v[76:79], v136 offset:2176
    v_min_u32 v210, s58, v210
    v_mfma_f32_16x16x32_bf16 v[52:55], a[168:171], v[108:111], v[52:55]
    s_mov_b32 s27, 172032
    buffer_load_dwordx4 v240, s[48:51], s27 offen offset:0 lds
    v_min_u32 v211, s58, v211
    v_mfma_f32_16x16x32_bf16 v[56:59], a[172:175], v[108:111], v[56:59]
    buffer_store_dwordx4 v[208:211], v9, s[4:7], s71 offen sc1
    v_mfma_f32_16x16x32_bf16 v[60:63], a[176:179], v[108:111], v[60:63]
    s_waitcnt lgkmcnt(7)
    buffer_load_dwordx4 v241, s[48:51], s27 offen offset:1024 lds
    s_barrier
    v_mfma_f32_16x16x32_bf16 v[48:51], a[160:163], v[112:115], v[48:51]
    ds_read_b128 v[80:83], v136 offset:1664
    v_mfma_f32_16x16x32_bf16 v[52:55], a[164:167], v[112:115], v[52:55]
    buffer_load_dwordx4 v242, s[48:51], s27 offen offset:2048 lds
    v_mfma_f32_16x16x32_bf16 v[56:59], a[168:171], v[112:115], v[56:59]
    v_mfma_f32_16x16x32_bf16 v[60:63], a[172:175], v[112:115], v[60:63]
    s_waitcnt lgkmcnt(7)
    buffer_load_dwordx4 v243, s[48:51], s27 offen offset:3072 lds
    s_add_u32 m0, s19, 16384
    v_mfma_f32_16x16x32_bf16 v[52:55], a[160:163], v[116:119], v[52:55]
    s_mov_b32 s27, 229376
    ds_read_b128 v[84:87], v136 offset:1152
    v_mfma_f32_16x16x32_bf16 v[56:59], a[164:167], v[116:119], v[56:59]
    buffer_load_dwordx4 v240, s[48:51], s27 offen offset:0 lds
    v_mfma_f32_16x16x32_bf16 v[60:63], a[168:171], v[116:119], v[60:63]
    s_waitcnt lgkmcnt(7)
    v_mfma_f32_16x16x32_bf16 v[56:59], a[160:163], v[120:123], v[56:59]
    ds_read_b128 v[88:91], v136 offset:640
    v_mfma_f32_16x16x32_bf16 v[60:63], a[164:167], v[120:123], v[60:63]
    s_waitcnt lgkmcnt(7)
    buffer_load_dwordx4 v241, s[48:51], s27 offen offset:1024 lds
    v_mfma_f32_16x16x32_bf16 v[60:63], a[160:163], v[124:127], v[60:63]
    s_waitcnt lgkmcnt(6)
    ds_read_b128 v[92:95], v136 offset:128
    v_mfma_f32_16x16x32_bf16 v[48:51], a[208:211], v[64:67], v[48:51]
    ds_read_b128 v[96:99], v136 offset:3776
    v_mfma_f32_16x16x32_bf16 v[52:55], a[212:215], v[64:67], v[52:55]
    buffer_load_dwordx4 v242, s[48:51], s27 offen offset:2048 lds
    v_mfma_f32_16x16x32_bf16 v[56:59], a[216:219], v[64:67], v[56:59]
    v_mfma_f32_16x16x32_bf16 v[60:63], a[220:223], v[64:67], v[60:63]
    s_waitcnt lgkmcnt(7)
    buffer_load_dwordx4 v243, s[48:51], s27 offen offset:3072 lds
    s_add_u32 m0, s19, 20480
    v_mfma_f32_16x16x32_bf16 v[48:51], a[204:207], v[68:71], v[48:51]
    s_mov_b32 s27, 286720
    ds_read_b128 v[100:103], v136 offset:3264
    v_mfma_f32_16x16x32_bf16 v[52:55], a[208:211], v[68:71], v[52:55]
    buffer_load_dwordx4 v240, s[48:51], s27 offen offset:0 lds
    v_mfma_f32_16x16x32_bf16 v[56:59], a[212:215], v[68:71], v[56:59]
    v_mfma_f32_16x16x32_bf16 v[60:63], a[216:219], v[68:71], v[60:63]
    s_waitcnt lgkmcnt(7)
    buffer_load_dwordx4 v241, s[48:51], s27 offen offset:1024 lds
    v_mfma_f32_16x16x32_bf16 v[48:51], a[200:203], v[72:75], v[48:51]
    ds_read_b128 v[104:107], v136 offset:2752
    v_mfma_f32_16x16x32_bf16 v[52:55], a[204:207], v[72:75], v[52:55]
    buffer_load_dwordx4 v242, s[48:51], s27 offen offset:2048 lds
    v_mfma_f32_16x16x32_bf16 v[56:59], a[208:211], v[72:75], v[56:59]
    v_mfma_f32_16x16x32_bf16 v[60:63], a[212:215], v[72:75], v[60:63]
    s_waitcnt lgkmcnt(7)
    buffer_load_dwordx4 v243, s[48:51], s27 offen offset:3072 lds
    s_add_u32 m0, s19, 24576
    v_mfma_f32_16x16x32_bf16 v[48:51], a[196:199], v[76:79], v[48:51]
    s_mov_b32 s27, 344064
    ds_read_b128 v[108:111], v136 offset:2240
    v_mfma_f32_16x16x32_bf16 v[52:55], a[200:203], v[76:79], v[52:55]
    buffer_load_dwordx4 v240, s[48:51], s27 offen offset:0 lds
    v_mfma_f32_16x16x32_bf16 v[56:59], a[204:207], v[76:79], v[56:59]
    v_mfma_f32_16x16x32_bf16 v[60:63], a[208:211], v[76:79], v[60:63]
    s_waitcnt lgkmcnt(7)
    buffer_load_dwordx4 v241, s[48:51], s27 offen offset:1024 lds
    v_mfma_f32_16x16x32_bf16 v[48:51], a[192:195], v[80:83], v[48:51]
    ds_read_b128 v[112:115], v136 offset:1728
    v_mfma_f32_16x16x32_bf16 v[52:55], a[196:199], v[80:83], v[52:55]
    buffer_load_dwordx4 v242, s[48:51], s27 offen offset:2048 lds
    v_mfma_f32_16x16x32_bf16 v[56:59], a[200:203], v[80:83], v[56:59]
    v_mfma_f32_16x16x32_bf16 v[60:63], a[204:207], v[80:83], v[60:63]
    s_waitcnt lgkmcnt(7)
    buffer_load_dwordx4 v243, s[48:51], s27 offen offset:3072 lds
    s_add_u32 m0, s19, 28672
    v_mfma_f32_16x16x32_bf16 v[52:55], a[192:195], v[84:87], v[52:55]
    s_mov_b32 s27, 401408
    ds_read_b128 v[116:119], v136 offset:1216
    v_mfma_f32_16x16x32_bf16 v[56:59], a[196:199], v[84:87], v[56:59]
    buffer_load_dwordx4 v240, s[48:51], s27 offen offset:0 lds
    v_mfma_f32_16x16x32_bf16 v[60:63], a[200:203], v[84:87], v[60:63]
    s_waitcnt lgkmcnt(7)
    v_mfma_f32_16x16x32_bf16 v[56:59], a[192:195], v[88:91], v[56:59]
    ds_read_b128 v[120:123], v136 offset:704
    v_mfma_f32_16x16x32_bf16 v[60:63], a[196:199], v[88:91], v[60:63]
    s_waitcnt lgkmcnt(7)
    buffer_load_dwordx4 v241, s[48:51], s27 offen offset:1024 lds
    v_mfma_f32_16x16x32_bf16 v[60:63], a[192:195], v[92:95], v[60:63]
    s_waitcnt lgkmcnt(6)
    ds_read_b128 v[124:127], v136 offset:192
    v_mfma_f32_16x16x32_bf16 v[48:51], a[240:243], v[96:99], v[48:51]
    s_waitcnt lgkmcnt(6)
    buffer_load_dwordx4 v242, s[48:51], s27 offen offset:2048 lds
    v_mfma_f32_16x16x32_bf16 v[48:51], a[236:239], v[100:103], v[48:51]
    s_waitcnt lgkmcnt(5)
    s_mov_b32 s62, 16777216
    v_mfma_f32_16x16x32_bf16 v[48:51], a[232:235], v[104:107], v[48:51]
    s_waitcnt lgkmcnt(4)
    buffer_load_dwordx4 v[176:179], v150, s[4:7], s62 offen offset:0 sc1
    v_mfma_f32_16x16x32_bf16 v[48:51], a[228:231], v[108:111], v[48:51]
    s_waitcnt lgkmcnt(3)
    buffer_load_dwordx4 v[160:163], v150, s[4:7], s62 offen offset:2048 sc1
    s_mov_b32 s62, 16781312
    v_mfma_f32_16x16x32_bf16 v[48:51], a[224:227], v[112:115], v[48:51]
    buffer_load_dwordx4 v[164:167], v150, s[4:7], s62 offen offset:0 sc1
    v_mfma_f32_16x16x32_bf16 v[52:55], a[244:247], v[96:99], v[52:55]
    buffer_load_dwordx4 v[24:27], v150, s[4:7], s62 offen offset:2048 sc1
    s_mov_b32 s62, 16785408
    v_mfma_f32_16x16x32_bf16 v[52:55], a[240:243], v[100:103], v[52:55]
    buffer_load_dwordx4 v[28:31], v150, s[4:7], s62 offen offset:0 sc1
    v_mfma_f32_16x16x32_bf16 v[52:55], a[236:239], v[104:107], v[52:55]
    s_nop 0
    ds_write_b128 v137, v[48:51] offset:0
    v_mfma_f32_16x16x32_bf16 v[52:55], a[232:235], v[108:111], v[52:55]
    buffer_load_dwordx4 v243, s[48:51], s27 offen offset:3072 lds
    v_mfma_f32_16x16x32_bf16 v[52:55], a[228:231], v[112:115], v[52:55]
    s_waitcnt lgkmcnt(3)
    v_bfe_u32 v18, v1, 3, 2
    v_mul_u32_u24 v18, 3584, v18
    v_mfma_f32_16x16x32_bf16 v[52:55], a[224:227], v[116:119], v[52:55]
    v_and_b32 v19, 7, v1
    v_lshl_add_u32 v18, v19, 7, v18
    v_mfma_f32_16x16x32_bf16 v[56:59], a[248:251], v[96:99], v[56:59]
    s_and_b32 s73, s3, 1
    s_lshl1_add_u32 s72, s47, s73
    s_mul_i32 s72, s72, 14336
    v_mfma_f32_16x16x32_bf16 v[56:59], a[244:247], v[100:103], v[56:59]
    s_add_u32 s62, s32, 0
    buffer_load_dwordx4 v[20:23], v151, s[4:7], s62 offen sc1
    s_and_b32 s73, s46, 3
    v_mfma_f32_16x16x32_bf16 v[56:59], a[240:243], v[104:107], v[56:59]
    s_mul_i32 s73, s73, 28
    ds_write_b128 v137, v[52:55] offset:1024
    s_lshr_b32 s73, s73, 3
    v_mfma_f32_16x16x32_bf16 v[56:59], a[236:239], v[108:111], v[56:59]
    s_lshl_b32 s73, s73, 8
    s_add_u32 s72, s72, s73
    s_add_u32 s72, s72, 917504
    v_mfma_f32_16x16x32_bf16 v[56:59], a[232:235], v[112:115], v[56:59]
    buffer_load_dword v159, v18, s[48:51], s72 offen
    s_mov_b32 s52, s34
    v_mfma_f32_16x16x32_bf16 v[56:59], a[228:231], v[116:119], v[56:59]
    s_waitcnt lgkmcnt(3)
    s_mov_b32 s53, s35
    s_mov_b32 s54, 0x1c0000
    v_mfma_f32_16x16x32_bf16 v[56:59], a[224:227], v[120:123], v[56:59]
    s_mov_b32 s55, 0x20000
    s_lshl2_add_u32 s72, s2, s3
    s_mul_i32 s72, s72, 1792
    v_mfma_f32_16x16x32_bf16 v[60:63], a[252:255], v[96:99], v[60:63]
    v_min_u32 v158, 13, v1
    v_lshlrev_b32 v158, 7, v158
    v_mfma_f32_16x16x32_bf16 v[60:63], a[248:251], v[100:103], v[60:63]
    buffer_load_dword v159, v158, s[52:55], s72 offen
    v_mfma_f32_16x16x32_bf16 v[60:63], a[244:247], v[104:107], v[60:63]
    ds_write_b128 v137, v[56:59] offset:2048
    v_mfma_f32_16x16x32_bf16 v[60:63], a[240:243], v[108:111], v[60:63]
    v_mfma_f32_16x16x32_bf16 v[60:63], a[236:239], v[112:115], v[60:63]
    v_mfma_f32_16x16x32_bf16 v[60:63], a[232:235], v[116:119], v[60:63]
    v_mfma_f32_16x16x32_bf16 v[60:63], a[228:231], v[120:123], v[60:63]
    s_waitcnt lgkmcnt(3)
    v_mfma_f32_16x16x32_bf16 v[60:63], a[224:227], v[124:127], v[60:63]
    s_nop 7
    ds_write_b128 v137, v[60:63] offset:3072
    s_waitcnt vmcnt(42)
    s_mov_b32 s67, 0x3f803f80
    v_mov_b32 v188, 0
    v_mov_b32 v189, 0
    v_mov_b32 v190, 0
    v_mov_b32 v191, 0
    v_dot2c_f32_bf16 v188, s67, v180
    v_dot2c_f32_bf16 v189, v180, v180
    v_dot2c_f32_bf16 v190, s67, v184
    v_dot2c_f32_bf16 v191, v184, v184
    v_dot2c_f32_bf16 v188, s67, v181
    v_dot2c_f32_bf16 v189, v181, v181
    v_dot2c_f32_bf16 v190, s67, v185
    v_dot2c_f32_bf16 v191, v185, v185
    v_dot2c_f32_bf16 v188, s67, v182
    v_dot2c_f32_bf16 v189, v182, v182
    v_dot2c_f32_bf16 v190, s67, v186
    v_dot2c_f32_bf16 v191, v186, v186
    v_dot2c_f32_bf16 v188, s67, v183
    v_dot2c_f32_bf16 v189, v183, v183
    v_dot2c_f32_bf16 v190, s67, v187
    v_dot2c_f32_bf16 v191, v187, v187
    v_lshlrev_b32 v220, 16, v180
    v_and_b32 v221, s57, v180
    v_lshlrev_b32 v222, 16, v181
    v_and_b32 v223, s57, v181
    v_lshlrev_b32 v224, 16, v182
    v_and_b32 v225, s57, v182
    v_lshlrev_b32 v226, 16, v183
    v_and_b32 v227, s57, v183
    v_lshlrev_b32 v228, 16, v184
    v_and_b32 v229, s57, v184
    v_lshlrev_b32 v230, 16, v185
    v_and_b32 v231, s57, v185
    v_lshlrev_b32 v232, 16, v186
    v_and_b32 v233, s57, v186
    v_lshlrev_b32 v234, 16, v187
    v_and_b32 v235, s57, v187
    v_add_f32_dpp v188, v188, v188 quad_perm:[1,0,3,2] row_mask:0xf bank_mask:0xf
    v_add_f32_dpp v189, v189, v189 quad_perm:[1,0,3,2] row_mask:0xf bank_mask:0xf
    v_add_f32_dpp v190, v190, v190 quad_perm:[1,0,3,2] row_mask:0xf bank_mask:0xf
    v_add_f32_dpp v191, v191, v191 quad_perm:[1,0,3,2] row_mask:0xf bank_mask:0xf
    v_add_f32_dpp v188, v188, v188 quad_perm:[2,3,0,1] row_mask:0xf bank_mask:0xf
    v_add_f32_dpp v189, v189, v189 quad_perm:[2,3,0,1] row_mask:0xf bank_mask:0xf
    v_add_f32_dpp v190, v190, v190 quad_perm:[2,3,0,1] row_mask:0xf bank_mask:0xf
    v_add_f32_dpp v191, v191, v191 quad_perm:[2,3,0,1] row_mask:0xf bank_mask:0xf
    v_add_f32_dpp v188, v188, v188 row_half_mirror row_mask:0xf bank_mask:0xf
    v_add_f32_dpp v189, v189, v189 row_half_mirror row_mask:0xf bank_mask:0xf
    v_add_f32_dpp v190, v190, v190 row_half_mirror row_mask:0xf bank_mask:0xf
    v_add_f32_dpp v191, v191, v191 row_half_mirror row_mask:0xf bank_mask:0xf
    v_add_f32_dpp v188, v188, v188 row_mirror row_mask:0xf bank_mask:0xf
    v_add_f32_dpp v189, v189, v189 row_mirror row_mask:0xf bank_mask:0xf
    v_add_f32_dpp v190, v190, v190 row_mirror row_mask:0xf bank_mask:0xf
    v_add_f32_dpp v191, v191, v191 row_mirror row_mask:0xf bank_mask:0xf
    v_add_f32_dpp v188, v188, v188 row_bcast:15 row_mask:0xa bank_mask:0xf
    v_add_f32_dpp v189, v189, v189 row_bcast:15 row_mask:0xa bank_mask:0xf
    v_add_f32_dpp v190, v190, v190 row_bcast:15 row_mask:0xa bank_mask:0xf
    v_add_f32_dpp v191, v191, v191 row_bcast:15 row_mask:0xa bank_mask:0xf
    v_add_f32_dpp v188, v188, v188 row_bcast:31 row_mask:0xc bank_mask:0xf
    v_add_f32_dpp v189, v189, v189 row_bcast:31 row_mask:0xc bank_mask:0xf
    v_add_f32_dpp v190, v190, v190 row_bcast:31 row_mask:0xc bank_mask:0xf
    v_add_f32_dpp v191, v191, v191 row_bcast:31 row_mask:0xc bank_mask:0xf
    v_mul_f32 v188, 0x3b000000, v188
    v_mul_f32 v190, 0x3b000000, v190
    v_mul_f32 v189, 0x3b000000, v189
    v_mul_f32 v191, 0x3b000000, v191
    v_fma_f32 v189, -v188, v188, v189
    v_fma_f32 v191, -v190, v190, v191
    v_max_f32 v189, 0, v189
    v_max_f32 v191, 0, v191
    v_cvt_pk_bf16_f32 v192, v189, v188
    v_cvt_pk_bf16_f32 v193, v191, v190
    v_lshlrev_b32 v189, 16, v192
    v_lshlrev_b32 v191, 16, v193
    v_and_b32 v188, s57, v192
    v_and_b32 v190, s57, v193
    v_add_f32 v189, 0x3727c5ac, v189
    v_add_f32 v191, 0x3727c5ac, v191
    v_cvt_pk_bf16_f32 v192, v189, v189
    v_cvt_pk_bf16_f32 v193, v191, v191
    v_lshlrev_b32 v189, 16, v192
    v_lshlrev_b32 v191, 16, v193
    v_sqrt_f32 v189, v189
    v_sqrt_f32 v191, v191
    v_cvt_pk_bf16_f32 v192, v189, v189
    v_cvt_pk_bf16_f32 v193, v191, v191
    v_lshlrev_b32 v189, 16, v192
    v_lshlrev_b32 v191, 16, v193
    v_rcp_f32 v189, v189
    v_rcp_f32 v191, v191
    v_mul_f32 v188, -v188, v189
    v_mul_f32 v190, -v190, v191
    v_readlane_b32 s36, v189, 63
    v_readlane_b32 s37, v188, 63
    v_readlane_b32 s38, v191, 63
    v_readlane_b32 s39, v190, 63
    v_mov_b32 v192, s37
    s_nop 0
    v_mov_b32 v194, s39
    v_pk_fma_f32 v[212:213], v[220:221], s[36:37], v[192:193] op_sel_hi:[1,0,0]
    v_pk_fma_f32 v[214:215], v[222:223], s[36:37], v[192:193] op_sel_hi:[1,0,0]
    v_pk_fma_f32 v[216:217], v[224:225], s[36:37], v[192:193] op_sel_hi:[1,0,0]
    v_pk_fma_f32 v[218:219], v[226:227], s[36:37], v[192:193] op_sel_hi:[1,0,0]
    v_pk_fma_f32 v[248:249], v[228:229], s[38:39], v[194:195] op_sel_hi:[1,0,0]
    v_pk_fma_f32 v[250:251], v[230:231], s[38:39], v[194:195] op_sel_hi:[1,0,0]
    v_pk_fma_f32 v[252:253], v[232:233], s[38:39], v[194:195] op_sel_hi:[1,0,0]
    v_pk_fma_f32 v[254:255], v[234:235], s[38:39], v[194:195] op_sel_hi:[1,0,0]
    s_waitcnt vmcnt(3)
    s_barrier
    ds_read_b64_tr_b16 a[0:1], v140 offset:0
    ds_read_b64_tr_b16 a[2:3], v140 offset:1024
    ds_read_b64_tr_b16 a[4:5], v141 offset:0
    ds_read_b64_tr_b16 a[6:7], v141 offset:1024
    ds_read_b64_tr_b16 a[8:9], v142 offset:0
    ds_read_b64_tr_b16 a[10:11], v142 offset:1024
    ds_read_b64_tr_b16 a[12:13], v143 offset:0
    ds_read_b64_tr_b16 a[14:15], v143 offset:1024
    ds_read_b64_tr_b16 a[16:17], v140 offset:8192
    ds_read_b64_tr_b16 a[18:19], v140 offset:9216
    ds_read_b64_tr_b16 a[20:21], v141 offset:8192
    ds_read_b64_tr_b16 a[22:23], v141 offset:9216
    ds_read_b64_tr_b16 a[24:25], v142 offset:8192
    ds_read_b64_tr_b16 a[26:27], v142 offset:9216
    ds_read_b64_tr_b16 a[28:29], v143 offset:8192
    ds_read_b64_tr_b16 a[30:31], v143 offset:9216
    ds_read_b64_tr_b16 a[32:33], v140 offset:16384
    ds_read_b64_tr_b16 a[34:35], v140 offset:17408
    ds_read_b64_tr_b16 a[36:37], v141 offset:16384
    ds_read_b64_tr_b16 a[38:39], v141 offset:17408
    ds_read_b64_tr_b16 a[40:41], v142 offset:16384
    ds_read_b64_tr_b16 a[42:43], v142 offset:17408
    ds_read_b64_tr_b16 a[44:45], v143 offset:16384
    ds_read_b64_tr_b16 a[46:47], v143 offset:17408
    ds_read_b64_tr_b16 a[48:49], v140 offset:24576
    ds_read_b64_tr_b16 a[50:51], v140 offset:25600
    ds_read_b64_tr_b16 a[52:53], v141 offset:24576
    ds_read_b64_tr_b16 a[54:55], v141 offset:25600
    ds_read_b64_tr_b16 a[56:57], v142 offset:24576
    ds_read_b64_tr_b16 a[58:59], v142 offset:25600
    ds_read_b64_tr_b16 a[60:61], v143 offset:24576
    ds_read_b64_tr_b16 a[62:63], v143 offset:25600
    ds_read_b64_tr_b16 a[64:65], v140 offset:32768
    ds_read_b64_tr_b16 a[66:67], v140 offset:33792
    ds_read_b64_tr_b16 a[68:69], v141 offset:32768
    ds_read_b64_tr_b16 a[70:71], v141 offset:33792
    ds_read_b64_tr_b16 a[72:73], v142 offset:32768
    ds_read_b64_tr_b16 a[74:75], v142 offset:33792
    ds_read_b64_tr_b16 a[76:77], v143 offset:32768
    ds_read_b64_tr_b16 a[78:79], v143 offset:33792
    ds_read_b64_tr_b16 a[80:81], v140 offset:40960
    ds_read_b64_tr_b16 a[82:83], v140 offset:41984
    ds_read_b64_tr_b16 a[84:85], v141 offset:40960
    ds_read_b64_tr_b16 a[86:87], v141 offset:41984
    ds_read_b64_tr_b16 a[88:89], v142 offset:40960
    ds_read_b64_tr_b16 a[90:91], v142 offset:41984
    ds_read_b64_tr_b16 a[92:93], v143 offset:40960
    ds_read_b64_tr_b16 a[94:95], v143 offset:41984
    ds_read_b64_tr_b16 a[96:97], v140 offset:49152
    ds_read_b64_tr_b16 a[98:99], v140 offset:50176
    ds_read_b64_tr_b16 a[100:101], v141 offset:49152
    ds_read_b64_tr_b16 a[102:103], v141 offset:50176
    ds_read_b64_tr_b16 a[104:105], v142 offset:49152
    ds_read_b64_tr_b16 a[106:107], v142 offset:50176
    ds_read_b64_tr_b16 a[108:109], v143 offset:49152
    ds_read_b64_tr_b16 a[110:111], v143 offset:50176
    ds_read_b64_tr_b16 a[112:113], v140 offset:57344
    ds_read_b64_tr_b16 a[114:115], v140 offset:58368
    ds_read_b64_tr_b16 a[116:117], v141 offset:57344
    ds_read_b64_tr_b16 a[118:119], v141 offset:58368
    ds_read_b64_tr_b16 a[120:121], v142 offset:57344
    ds_read_b64_tr_b16 a[122:123], v142 offset:58368
    ds_read_b64_tr_b16 a[124:125], v143 offset:57344
    ds_read_b64_tr_b16 a[126:127], v143 offset:58368
    v_add_u32 v18, 156928, v152
    v_add_u32 v19, 156928, v153
    v_add_u32 v240, 917504, v240
    v_add_u32 v241, 917504, v241
    v_add_u32 v242, 917504, v242
    v_add_u32 v243, 917504, v243
    s_waitcnt vmcnt(4)
    v_max3_u32 v96, v176, v177, v178
    v_max3_u32 v96, v96, v179, v160
    v_max3_u32 v96, v96, v161, v162
    v_max3_u32 v96, v96, v163, v164
    v_max3_u32 v96, v96, v165, v166
    v_max3_u32 v96, v96, v167, v24
    v_max3_u32 v96, v96, v25, v26
    v_max3_u32 v96, v96, v27, v28
    v_max3_u32 v96, v96, v29, v30
    v_max_u32 v96, v96, v31
    v_cmp_eq_u32 vcc, -1, v96
    s_nop 0
    s_cbranch_vccnz L_slow3
L_back3:
    v_lshlrev_b32 v64, 16, v176
    v_and_b32 v65, s57, v176
    v_lshlrev_b32 v66, 16, v177
    v_and_b32 v67, s57, v177
    v_lshlrev_b32 v68, 16, v178
    v_and_b32 v69, s57, v178
    v_lshlrev_b32 v70, 16, v179
    v_and_b32 v71, s57, v179
    v_lshlrev_b32 v72, 16, v160
    v_and_b32 v73, s57, v160
    v_lshlrev_b32 v74, 16, v161
    v_and_b32 v75, s57, v161
    v_lshlrev_b32 v76, 16, v162
    v_and_b32 v77, s57, v162
    v_lshlrev_b32 v78, 16, v163
    v_and_b32 v79, s57, v163
    v_lshlrev_b32 v104, 16, v164
    v_and_b32 v105, s57, v164
    v_lshlrev_b32 v106, 16, v165
    v_and_b32 v107, s57, v165
    v_lshlrev_b32 v108, 16, v166
    v_and_b32 v109, s57, v166
    v_lshlrev_b32 v110, 16, v167
    v_and_b32 v111, s57, v167
    v_lshlrev_b32 v80, 16, v28
    v_and_b32 v81, s57, v28
    v_lshlrev_b32 v82, 16, v29
    v_and_b32 v83, s57, v29
    v_lshlrev_b32 v84, 16, v30
    v_and_b32 v85, s57, v30
    v_lshlrev_b32 v86, 16, v31
    v_and_b32 v87, s57, v31
    v_lshlrev_b32 v88, 16, v24
    v_and_b32 v89, s57, v24
    v_lshlrev_b32 v90, 16, v25
    v_and_b32 v91, s57, v25
    v_lshlrev_b32 v92, 16, v26
    v_and_b32 v93, s57, v26
    v_lshlrev_b32 v94, 16, v27
    v_and_b32 v95, s57, v27
    v_pk_mul_f32 v[64:65], v[64:65], v[104:105]
    v_pk_mul_f32 v[66:67], v[66:67], v[106:107]
    v_pk_mul_f32 v[68:69], v[68:69], v[108:109]
    v_pk_mul_f32 v[70:71], v[70:71], v[110:111]
    v_pk_mul_f32 v[72:73], v[72:73], v[104:105]
    v_pk_mul_f32 v[74:75], v[74:75], v[106:107]
    v_pk_mul_f32 v[76:77], v[76:77], v[108:109]
    v_pk_mul_f32 v[78:79], v[78:79], v[110:111]
    s_waitcnt vmcnt(2)
    v_max3_u32 v96, v20, v21, v22
    v_max_u32 v96, v96, v23
    v_cmp_eq_u32 vcc, -1, v96
    s_nop 0
    s_cbranch_vccnz L_slow4
L_back4:
    ds_write2st64_b32 v18, v20, v21 offset0:0 offset1:4
    ds_write2st64_b32 v18, v22, v23 offset0:8 offset1:12
    v_pk_fma_f32 v[212:213], v[212:213], v[72:73], v[64:65]
    v_pk_fma_f32 v[214:215], v[214:215], v[74:75], v[66:67]
    v_pk_fma_f32 v[216:217], v[216:217], v[76:77], v[68:69]
    v_pk_fma_f32 v[218:219], v[218:219], v[78:79], v[70:71]
    v_pk_fma_f32 v[248:249], v[248:249], v[72:73], v[64:65]
    v_pk_fma_f32 v[250:251], v[250:251], v[74:75], v[66:67]
    v_pk_fma_f32 v[252:253], v[252:253], v[76:77], v[68:69]
    v_pk_fma_f32 v[254:255], v[254:255], v[78:79], v[70:71]
    s_waitcnt lgkmcnt(0)
    s_barrier
    ds_read_b128 v[32:35], v19
    s_mov_b32 s62, 17039360
    buffer_load_dword v236, v148, s[4:7], s62 offen sc1
    ds_read_b128 v[192:195], v138 offset:0
    ds_read_b128 v[196:199], v138 offset:4096
    ds_read_b128 v[200:203], v138 offset:8192
    ds_read_b128 v[204:207], v138 offset:12288
    s_add_u32 m0, s19, 0
    s_mov_b32 s27, 0
    buffer_load_dwordx4 v240, s[48:51], s27 offen offset:0 lds
    buffer_load_dwordx4 v241, s[48:51], s27 offen offset:1024 lds
    s_waitcnt lgkmcnt(4)
    v_mov_b32 v48, 0
    v_mov_b32 v49, 0
    v_lshlrev_b32 v36, 16, v32
    v_and_b32 v37, s57, v32
    v_lshlrev_b32 v38, 16, v33
    v_and_b32 v39, s57, v33
    v_lshlrev_b32 v40, 16, v34
    v_and_b32 v41, s57, v34
    v_lshlrev_b32 v42, 16, v35
    v_and_b32 v43, s57, v35
    v_pk_fma_f32 v[36:37], v[36:37], v[212:213], v[220:221]
    v_pk_fma_f32 v[38:39], v[38:39], v[214:215], v[222:223]
    v_pk_fma_f32 v[40:41], v[40:41], v[216:217], v[224:225]
    v_pk_fma_f32 v[42:43], v[42:43], v[218:219], v[226:227]
    v_cvt_pk_bf16_f32 v176, v36, v37
    v_cvt_pk_bf16_f32 v177, v38, v39
    v_cvt_pk_bf16_f32 v178, v40, v41
    v_cvt_pk_bf16_f32 v179, v42, v43
    v_dot2c_f32_bf16 v48, s67, v176
    v_dot2c_f32_bf16 v49, v176, v176
    v_dot2c_f32_bf16 v48, s67, v177
    v_dot2c_f32_bf16 v49, v177, v177
    v_dot2c_f32_bf16 v48, s67, v178
    v_dot2c_f32_bf16 v49, v178, v178
    buffer_load_dwordx4 v242, s[48:51], s27 offen offset:2048 lds
    v_dot2c_f32_bf16 v48, s67, v179
    v_dot2c_f32_bf16 v49, v179, v179
    s_add_u32 s66, s68, 4194304
    s_nop 0
    v_add_f32_dpp v48, v48, v48 quad_perm:[1,0,3,2] row_mask:0xf bank_mask:0xf
    v_add_f32_dpp v49, v49, v49 quad_perm:[1,0,3,2] row_mask:0xf bank_mask:0xf
    s_nop 0
    v_add_f32_dpp v48, v48, v48 quad_perm:[2,3,0,1] row_mask:0xf bank_mask:0xf
    v_add_f32_dpp v49, v49, v49 quad_perm:[2,3,0,1] row_mask:0xf bank_mask:0xf
    s_nop 0
    v_add_f32_dpp v48, v48, v48 row_half_mirror row_mask:0xf bank_mask:0xf
    v_add_f32_dpp v49, v49, v49 row_half_mirror row_mask:0xf bank_mask:0xf
    s_nop 0
    v_add_f32_dpp v48, v48, v48 row_mirror row_mask:0xf bank_mask:0xf
    v_add_f32_dpp v49, v49, v49 row_mirror row_mask:0xf bank_mask:0xf
    s_nop 0
    v_add_f32_dpp v48, v48, v48 row_bcast:15 row_mask:0xa bank_mask:0xf
    v_add_f32_dpp v49, v49, v49 row_bcast:15 row_mask:0xa bank_mask:0xf
    s_nop 0
    v_add_f32_dpp v48, v48, v48 row_bcast:31 row_mask:0xc bank_mask:0xf
    v_add_f32_dpp v49, v49, v49 row_bcast:31 row_mask:0xc bank_mask:0xf
    v_mul_f32 v48, 0x3b000000, v48
    v_mul_f32 v49, 0x3b000000, v49
    v_fma_f32 v49, -v48, v48, v49
    v_max_f32 v49, 0, v49
    v_cvt_pk_bf16_f32 v50, v49, v48
    v_lshlrev_b32 v49, 16, v50
    v_and_b32 v48, s57, v50
    v_add_f32 v49, 0x3727c5ac, v49
    v_cvt_pk_bf16_f32 v50, v49, v49
    buffer_load_dwordx4 v243, s[48:51], s27 offen offset:3072 lds
    v_lshlrev_b32 v49, 16, v50
    v_sqrt_f32 v49, v49
    s_nop 0
    v_cvt_pk_bf16_f32 v50, v49, v49
    v_lshlrev_b32 v49, 16, v50
    v_rcp_f32 v49, v49
    s_nop 0
    v_mul_f32 v48, -v48, v49
    v_readlane_b32 s72, v49, 63
    v_readlane_b32 s73, v48, 63
    s_nop 1
    v_mov_b32 v48, s73
    v_pk_fma_f32 v[36:37], v[36:37], s[72:73], v[48:49] op_sel_hi:[1,0,0]
    v_pk_fma_f32 v[38:39], v[38:39], s[72:73], v[48:49] op_sel_hi:[1,0,0]
    v_pk_fma_f32 v[40:41], v[40:41], s[72:73], v[48:49] op_sel_hi:[1,0,0]
    v_pk_fma_f32 v[42:43], v[42:43], s[72:73], v[48:49] op_sel_hi:[1,0,0]
    v_pk_fma_f32 v[36:37], v[36:37], v[80:81], v[88:89]
    v_pk_fma_f32 v[38:39], v[38:39], v[82:83], v[90:91]
    v_pk_fma_f32 v[40:41], v[40:41], v[84:85], v[92:93]
    v_pk_fma_f32 v[42:43], v[42:43], v[86:87], v[94:95]
    v_cvt_pk_bf16_f32 v44, v36, v37
    v_cvt_pk_bf16_f32 v45, v38, v39
    v_cvt_pk_bf16_f32 v46, v40, v41
    v_cvt_pk_bf16_f32 v47, v42, v43
    v_min_u32 v44, s58, v44
    v_min_u32 v45, s58, v45
    v_min_u32 v46, s58, v46
    s_add_u32 m0, s19, 4096
    s_mov_b32 s27, 57344
    buffer_load_dwordx4 v240, s[48:51], s27 offen offset:0 lds
    v_min_u32 v47, s58, v47
    buffer_store_dwordx4 v[44:47], v2, s[4:7], s66 offen sc1
    s_waitcnt lgkmcnt(0)
    v_pk_add_f32 v[192:193], v[192:193], v[196:197]
    v_pk_add_f32 v[194:195], v[194:195], v[198:199]
    v_pk_fma_f32 v[192:193], v[168:169], s[44:45], v[192:193] op_sel:[0,0,0] op_sel_hi:[1,0,1]
    v_pk_fma_f32 v[194:195], v[170:171], s[44:45], v[194:195] op_sel:[0,0,0] op_sel_hi:[1,0,1]
    v_pk_add_f32 v[200:201], v[200:201], v[204:205]
    v_pk_add_f32 v[202:203], v[202:203], v[206:207]
    v_pk_fma_f32 v[200:201], v[172:173], s[44:45], v[200:201] op_sel:[0,1,0] op_sel_hi:[1,1,1]
    v_pk_fma_f32 v[202:203], v[174:175], s[44:45], v[202:203] op_sel:[0,1,0] op_sel_hi:[1,1,1]
    s_add_u32 s71, s71, 1048576
    v_cvt_pk_bf16_f32 v208, v192, v200
    v_cvt_pk_bf16_f32 v209, v193, v201
    v_cvt_pk_bf16_f32 v210, v194, v202
    v_cvt_pk_bf16_f32 v211, v195, v203
    v_min_u32 v208, s58, v208
    v_min_u32 v209, s58, v209
    v_min_u32 v210, s58, v210
    v_min_u32 v211, s58, v211
    buffer_store_dwordx4 v[208:211], v9, s[4:7], s71 offen sc1
    s_lshl_b32 s70, s59, 14
    buffer_load_dwordx4 v241, s[48:51], s27 offen offset:1024 lds
    s_lshl_b32 s69, s3, 12
    s_add_u32 s70, s70, s69
    s_add_u32 s70, s70, 4194304
    s_add_u32 s70, s70, s75
    s_add_u32 s69, s69, 98304
    s_lshl_b32 s63, s3, 6
    v_xor_b32 v108, s63, v2
    buffer_load_dwordx4 v242, s[48:51], s27 offen offset:2048 lds
    v_xor_b32 v109, 16, v108
    v_xor_b32 v110, 32, v108
    v_xor_b32 v111, 48, v108
    s_lshr_b32 s16, s47, 2
    s_xor_b32 s16, s16, 4
    s_and_b32 s60, s47, 3
    s_lshl_b32 s63, s46, 1
    buffer_load_dwordx4 v243, s[48:51], s27 offen offset:3072 lds
    s_lshr_b32 s62, s60, 1
    s_add_u32 s63, s63, s62
    s_lshl_b32 s25, s63, 13
    s_mul_i32 s62, s3, 1792
    s_add_u32 s25, s25, s62
    s_and_b32 s60, s60, 1
    s_lshl_b32 s60, s60, 4
    s_add_u32 m0, s19, 8192
    s_mov_b32 s27, 114688
    buffer_load_dwordx4 v240, s[48:51], s27 offen offset:0 lds
    s_add_u32 s17, s60, s63
    s_mul_i32 s24, s17, 56
    s_mul_i32 s60, s3, 14
    s_add_u32 s24, s24, s60
    s_lshl_b32 s24, s24, 10
    s_add_u32 s24, s24, 8388608
    s_mul_i32 s60, s59, 56
    buffer_load_dwordx4 v241, s[48:51], s27 offen offset:1024 lds
    s_add_u32 s60, s60, s28
    s_lshl_b32 s60, s60, 10
    s_add_u32 s60, s60, s75
    s_add_u32 s65, s60, 8388608
    s_lshl_b32 s61, s59, 13
    s_lshl_b32 s60, s28, 7
    s_add_u32 s61, s61, s60
    buffer_load_dwordx4 v242, s[48:51], s27 offen offset:2048 lds
    s_and_b32 s60, s64, 1073741824
    s_lshl_b32 s62, s22, 7
    s_add_u32 s64, s62, s60
    v_xor_b32 v3, v6, v5
    v_lshlrev_b32 v3, 4, v3
    v_lshl_add_u32 v3, v5, 10, v3
    v_add_u32 v104, 98304, v3
    buffer_load_dwordx4 v243, s[48:51], s27 offen offset:3072 lds
    v_xor_b32 v105, 64, v104
    v_xor_b32 v106, 128, v104
    v_xor_b32 v107, 192, v104
    v_add_u32 v3, s69, v2
    s_waitcnt vmcnt(14)
    v_cmp_ne_u32 vcc, s56, v236
    s_nop 0
    s_cbranch_vccnz L_slow5
L_back5:
    s_barrier
    s_add_u32 m0, s19, 12288
    s_mov_b32 s27, 172032
    buffer_load_dwordx4 v240, s[48:51], s27 offen offset:0 lds
    buffer_load_dwordx4 v241, s[48:51], s27 offen offset:1024 lds
    buffer_load_dwordx4 v242, s[48:51], s27 offen offset:2048 lds
    buffer_load_dwordx4 v243, s[48:51], s27 offen offset:3072 lds
    s_add_u32 m0, s19, 16384
    s_mov_b32 s27, 229376
    buffer_load_dwordx4 v240, s[48:51], s27 offen offset:0 lds
    buffer_load_dwordx4 v241, s[48:51], s27 offen offset:1024 lds
    buffer_load_dwordx4 v242, s[48:51], s27 offen offset:2048 lds
    buffer_load_dwordx4 v243, s[48:51], s27 offen offset:3072 lds
    s_add_u32 m0, s19, 20480
    s_mov_b32 s27, 286720
    buffer_load_dwordx4 v240, s[48:51], s27 offen offset:0 lds
    buffer_load_dwordx4 v241, s[48:51], s27 offen offset:1024 lds
    buffer_load_dwordx4 v242, s[48:51], s27 offen offset:2048 lds
    buffer_load_dwordx4 v243, s[48:51], s27 offen offset:3072 lds
    s_add_u32 m0, s19, 24576
    s_mov_b32 s27, 344064
    buffer_load_dwordx4 v240, s[48:51], s27 offen offset:0 lds
    buffer_load_dwordx4 v241, s[48:51], s27 offen offset:1024 lds
    buffer_load_dwordx4 v242, s[48:51], s27 offen offset:2048 lds
    buffer_load_dwordx4 v243, s[48:51], s27 offen offset:3072 lds
    s_add_u32 m0, s19, 28672
    s_mov_b32 s27, 401408
    buffer_load_dwordx4 v240, s[48:51], s27 offen offset:0 lds
    buffer_load_dwordx4 v241, s[48:51], s27 offen offset:1024 lds
    buffer_load_dwordx4 v242, s[48:51], s27 offen offset:2048 lds
    buffer_load_dwordx4 v243, s[48:51], s27 offen offset:3072 lds
    s_add_u32 m0, s69, 32768
    s_add_u32 s63, s70, 0
    buffer_load_dwordx4 v108, s[4:7], s63 offen offset:0 sc1 lds
    buffer_load_dwordx4 v109, s[4:7], s63 offen offset:1024 sc1 lds
    buffer_load_dwordx4 v110, s[4:7], s63 offen offset:2048 sc1 lds
    buffer_load_dwordx4 v111, s[4:7], s63 offen offset:3072 sc1 lds
    s_add_u32 s62, s32, 1048576
    buffer_load_dwordx4 v[156:159], v151, s[4:7], s62 offen sc1
    s_add_u32 m0, s69, 49152
    s_add_u32 s63, s70, 262144
    buffer_load_dwordx4 v108, s[4:7], s63 offen offset:0 sc1 lds
    buffer_load_dwordx4 v109, s[4:7], s63 offen offset:1024 sc1 lds
    buffer_load_dwordx4 v110, s[4:7], s63 offen offset:2048 sc1 lds
    buffer_load_dwordx4 v111, s[4:7], s63 offen offset:3072 sc1 lds
    s_mov_b32 s48, s34
    s_mov_b32 s49, s35
    s_mov_b32 s50, 0x1c0000
    s_mov_b32 s51, 0x20000
    s_mul_i32 s18, s3, 458752
    s_lshl_b32 s60, s16, 7
    s_add_u32 s18, s18, s60
    s_mul_i32 s19, s3, 24576
    v_bfe_u32 v120, v1, 1, 2
    v_xor_b32 v120, v120, v6
    v_and_b32 v121, 1, v1
    v_lshl_add_u32 v120, v120, 1, v121
    v_lshlrev_b32 v121, 10, v4
    v_lshl_add_u32 v116, v120, 4, v121
    v_add_u32 v117, 7168, v116
    v_add_u32 v118, 14336, v116
    v_add_u32 v119, 21504, v116
    v_lshrrev_b32 v120, 2, v1
    v_lshlrev_b32 v120, 7, v120
    v_and_b32 v121, 3, v1
    v_lshl_add_u32 v120, v121, 3, v120
    v_add_u32 v120, s19, v120
    v_bfe_u32 v121, v1, 3, 2
    v_xor_b32 v122, 0, v121
    v_lshl_add_u32 v124, v122, 5, v120
    v_xor_b32 v122, 1, v121
    v_lshl_add_u32 v125, v122, 5, v120
    v_xor_b32 v122, 2, v121
    v_lshl_add_u32 v126, v122, 5, v120
    v_xor_b32 v122, 3, v121
    v_lshl_add_u32 v127, v122, 5, v120
    v_add_u32 v152, 94208, v152
    v_add_u32 v153, 94208, v153
    s_waitcnt vmcnt(9)
    s_barrier
    s_cmp_lg_u32 s75, 0
    s_cbranch_scc1 L_spare
    ds_read_b64_tr_b16 a[128:129], v140 offset:0
    ds_read_b64_tr_b16 a[130:131], v140 offset:1024
    ds_read_b64_tr_b16 a[132:133], v141 offset:0
    ds_read_b64_tr_b16 a[134:135], v141 offset:1024
    ds_read_b64_tr_b16 a[136:137], v142 offset:0
    ds_read_b64_tr_b16 a[138:139], v142 offset:1024
    ds_read_b64_tr_b16 a[140:141], v143 offset:0
    ds_read_b64_tr_b16 a[142:143], v143 offset:1024
    ds_read_b64_tr_b16 a[144:145], v140 offset:8192
    ds_read_b64_tr_b16 a[146:147], v140 offset:9216
    ds_read_b64_tr_b16 a[148:149], v141 offset:8192
    ds_read_b64_tr_b16 a[150:151], v141 offset:9216
    ds_read_b64_tr_b16 a[152:153], v142 offset:8192
    ds_read_b64_tr_b16 a[154:155], v142 offset:9216
    ds_read_b64_tr_b16 a[156:157], v143 offset:8192
    ds_read_b64_tr_b16 a[158:159], v143 offset:9216
    ds_read_b64_tr_b16 a[160:161], v140 offset:16384
    ds_read_b64_tr_b16 a[162:163], v140 offset:17408
    ds_read_b64_tr_b16 a[164:165], v141 offset:16384
    ds_read_b64_tr_b16 a[166:167], v141 offset:17408
    ds_read_b64_tr_b16 a[168:169], v142 offset:16384
    ds_read_b64_tr_b16 a[170:171], v142 offset:17408
    ds_read_b64_tr_b16 a[172:173], v143 offset:16384
    ds_read_b64_tr_b16 a[174:175], v143 offset:17408
    ds_read_b64_tr_b16 a[176:177], v140 offset:24576
    ds_read_b64_tr_b16 a[178:179], v140 offset:25600
    ds_read_b64_tr_b16 a[180:181], v141 offset:24576
    ds_read_b64_tr_b16 a[182:183], v141 offset:25600
    ds_read_b64_tr_b16 a[184:185], v142 offset:24576
    ds_read_b64_tr_b16 a[186:187], v142 offset:25600
    ds_read_b64_tr_b16 a[188:189], v143 offset:24576
    ds_read_b64_tr_b16 a[190:191], v143 offset:25600
    ds_read_b64_tr_b16 a[192:193], v140 offset:32768
    ds_read_b64_tr_b16 a[194:195], v140 offset:33792
    ds_read_b64_tr_b16 a[196:197], v141 offset:32768
    ds_read_b64_tr_b16 a[198:199], v141 offset:33792
    ds_read_b64_tr_b16 a[200:201], v142 offset:32768
    ds_read_b64_tr_b16 a[202:203], v142 offset:33792
    ds_read_b64_tr_b16 a[204:205], v143 offset:32768
    ds_read_b64_tr_b16 a[206:207], v143 offset:33792
    ds_read_b64_tr_b16 a[208:209], v140 offset:40960
    ds_read_b64_tr_b16 a[210:211], v140 offset:41984
    ds_read_b64_tr_b16 a[212:213], v141 offset:40960
    ds_read_b64_tr_b16 a[214:215], v141 offset:41984
    ds_read_b64_tr_b16 a[216:217], v142 offset:40960
    ds_read_b64_tr_b16 a[218:219], v142 offset:41984
    ds_read_b64_tr_b16 a[220:221], v143 offset:40960
    ds_read_b64_tr_b16 a[222:223], v143 offset:41984
    ds_read_b64_tr_b16 a[224:225], v140 offset:49152
    ds_read_b64_tr_b16 a[226:227], v140 offset:50176
    ds_read_b64_tr_b16 a[228:229], v141 offset:49152
    ds_read_b64_tr_b16 a[230:231], v141 offset:50176
    ds_read_b64_tr_b16 a[232:233], v142 offset:49152
    ds_read_b64_tr_b16 a[234:235], v142 offset:50176
    ds_read_b64_tr_b16 a[236:237], v143 offset:49152
    ds_read_b64_tr_b16 a[238:239], v143 offset:50176
    ds_read_b64_tr_b16 a[240:241], v140 offset:57344
    ds_read_b64_tr_b16 a[242:243], v140 offset:58368
    ds_read_b64_tr_b16 a[244:245], v141 offset:57344
    ds_read_b64_tr_b16 a[246:247], v141 offset:58368
    ds_read_b64_tr_b16 a[248:249], v142 offset:57344
    ds_read_b64_tr_b16 a[250:251], v142 offset:58368
    ds_read_b64_tr_b16 a[252:253], v143 offset:57344
    ds_read_b64_tr_b16 a[254:255], v143 offset:58368
    s_waitcnt vmcnt(5)
    ds_read_b128 v[64:67], v3 offset:32768
    ds_read_b128 v[68:71], v3 offset:33792
    ds_read_b128 v[72:75], v3 offset:34816
    ds_read_b128 v[76:79], v3 offset:35840
    s_waitcnt lgkmcnt(0)
    v_max3_u32 v14, v64, v65, v66
    v_max3_u32 v14, v14, v67, v68
    v_max3_u32 v14, v14, v69, v70
    v_max3_u32 v14, v14, v71, v72
    v_max3_u32 v14, v14, v73, v74
    v_max3_u32 v14, v14, v75, v76
    v_max3_u32 v14, v14, v77, v78
    v_max_u32 v14, v14, v79
    v_cmp_eq_u32 vcc, -1, v14
    s_nop 0
    s_cbranch_vccnz L_slow6
L_back6:
    s_barrier
    s_waitcnt vmcnt(4)
    v_max3_u32 v14, v156, v157, v158
    v_max_u32 v14, v14, v159
    v_cmp_eq_u32 vcc, -1, v14
    s_nop 0
    s_cbranch_vccnz L_slow7
L_back7:
    ds_write2st64_b32 v152, v156, v157 offset0:0 offset1:4
    ds_write2st64_b32 v152, v158, v159 offset0:8 offset1:12
    s_waitcnt lgkmcnt(0)
    s_barrier
    ds_read_b128 v[156:159], v153
    ds_read_b128 v[16:19], v104 offset:32768
    ds_read_b128 v[20:23], v105 offset:32768
    ds_read_b128 v[24:27], v106 offset:32768
    s_waitcnt lgkmcnt(2)
    v_mfma_f32_16x16x32_bf16 v[32:35], a[0:3], v[16:19], 0
    s_add_u32 m0, s69, 0
    ds_read_b128 v[28:31], v107 offset:32768
    v_mov_b32 v172, 0
    v_mfma_f32_16x16x32_bf16 v[36:39], a[4:7], v[16:19], 0
    s_add_u32 s63, s70, 524288
    buffer_load_dwordx4 v108, s[4:7], s63 offen offset:0 sc1 lds
    v_mov_b32 v173, 0
    v_mfma_f32_16x16x32_bf16 v[40:43], a[8:11], v[16:19], 0
    v_lshlrev_b32 v160, 16, v156
    v_and_b32 v161, s57, v156
    v_mfma_f32_16x16x32_bf16 v[44:47], a[12:15], v[16:19], 0
    s_waitcnt lgkmcnt(2)
    v_lshlrev_b32 v162, 16, v157
    v_and_b32 v163, s57, v157
    v_mfma_f32_16x16x32_bf16 v[32:35], a[16:19], v[20:23], v[32:35]
    ds_read_b128 v[16:19], v104 offset:33024
    v_lshlrev_b32 v164, 16, v158
    v_mfma_f32_16x16x32_bf16 v[36:39], a[20:23], v[20:23], v[36:39]
    buffer_load_dwordx4 v109, s[4:7], s63 offen offset:1024 sc1 lds
    v_and_b32 v165, s57, v158
    v_mfma_f32_16x16x32_bf16 v[40:43], a[24:27], v[20:23], v[40:43]
    v_lshlrev_b32 v166, 16, v159
    v_and_b32 v167, s57, v159
    v_mfma_f32_16x16x32_bf16 v[44:47], a[28:31], v[20:23], v[44:47]
    s_waitcnt lgkmcnt(2)
    v_fma_f32 v160, v160, v248, v228
    v_fma_f32 v161, v161, v249, v229
    v_mfma_f32_16x16x32_bf16 v[32:35], a[32:35], v[24:27], v[32:35]
    ds_read_b128 v[20:23], v105 offset:33024
    v_fma_f32 v162, v162, v250, v230
    v_mfma_f32_16x16x32_bf16 v[36:39], a[36:39], v[24:27], v[36:39]
    buffer_load_dwordx4 v110, s[4:7], s63 offen offset:2048 sc1 lds
    v_fma_f32 v163, v163, v251, v231
    v_mfma_f32_16x16x32_bf16 v[40:43], a[40:43], v[24:27], v[40:43]
    v_fma_f32 v164, v164, v252, v232
    v_fma_f32 v165, v165, v253, v233
    v_mfma_f32_16x16x32_bf16 v[44:47], a[44:47], v[24:27], v[44:47]
    s_waitcnt lgkmcnt(2)
    v_fma_f32 v166, v166, v254, v234
    v_fma_f32 v167, v167, v255, v235
    v_mfma_f32_16x16x32_bf16 v[32:35], a[48:51], v[28:31], v[32:35]
    ds_read_b128 v[24:27], v106 offset:33024
    v_cvt_pk_bf16_f32 v188, v160, v161
    v_mfma_f32_16x16x32_bf16 v[36:39], a[52:55], v[28:31], v[36:39]
    buffer_load_dwordx4 v111, s[4:7], s63 offen offset:3072 sc1 lds
    v_cvt_pk_bf16_f32 v189, v162, v163
    v_mfma_f32_16x16x32_bf16 v[40:43], a[56:59], v[28:31], v[40:43]
    s_add_u32 m0, s19, 0
    v_cvt_pk_bf16_f32 v190, v164, v165
    v_cvt_pk_bf16_f32 v191, v166, v167
    v_mfma_f32_16x16x32_bf16 v[44:47], a[60:63], v[28:31], v[44:47]
    s_waitcnt lgkmcnt(2)
    v_dot2c_f32_bf16 v172, s67, v188
    v_dot2c_f32_bf16 v173, v188, v188
    v_mfma_f32_16x16x32_bf16 v[32:35], a[64:67], v[16:19], v[32:35]
    ds_read_b128 v[28:31], v107 offset:33024
    v_dot2c_f32_bf16 v172, s67, v189
    v_mfma_f32_16x16x32_bf16 v[36:39], a[68:71], v[16:19], v[36:39]
    buffer_load_dwordx4 v116, s[48:51], s18 offen offset:0 lds
    v_dot2c_f32_bf16 v173, v189, v189
    v_mfma_f32_16x16x32_bf16 v[40:43], a[72:75], v[16:19], v[40:43]
    v_dot2c_f32_bf16 v172, s67, v190
    v_dot2c_f32_bf16 v173, v190, v190
    v_mfma_f32_16x16x32_bf16 v[44:47], a[76:79], v[16:19], v[44:47]
    s_waitcnt lgkmcnt(2)
    v_dot2c_f32_bf16 v172, s67, v191
    v_dot2c_f32_bf16 v173, v191, v191
    v_mfma_f32_16x16x32_bf16 v[32:35], a[80:83], v[20:23], v[32:35]
    s_add_u32 s66, s68, 5242880
    ds_read_b128 v[16:19], v104 offset:33280
    v_add_f32_dpp v172, v172, v172 quad_perm:[1,0,3,2] row_mask:0xf bank_mask:0xf
    v_mfma_f32_16x16x32_bf16 v[36:39], a[84:87], v[20:23], v[36:39]
    buffer_load_dwordx4 v117, s[48:51], s18 offen offset:1024 lds
    v_add_f32_dpp v173, v173, v173 quad_perm:[1,0,3,2] row_mask:0xf bank_mask:0xf
    v_mfma_f32_16x16x32_bf16 v[40:43], a[88:91], v[20:23], v[40:43]
    v_add_f32_dpp v172, v172, v172 quad_perm:[2,3,0,1] row_mask:0xf bank_mask:0xf
    v_add_f32_dpp v173, v173, v173 quad_perm:[2,3,0,1] row_mask:0xf bank_mask:0xf
    v_mfma_f32_16x16x32_bf16 v[44:47], a[92:95], v[20:23], v[44:47]
    s_waitcnt lgkmcnt(2)
    v_add_f32_dpp v172, v172, v172 row_half_mirror row_mask:0xf bank_mask:0xf
    v_add_f32_dpp v173, v173, v173 row_half_mirror row_mask:0xf bank_mask:0xf
    v_mfma_f32_16x16x32_bf16 v[32:35], a[96:99], v[24:27], v[32:35]
    s_waitcnt vmcnt(6)
    ds_read_b128 v[20:23], v105 offset:33280
    v_add_f32_dpp v172, v172, v172 row_mirror row_mask:0xf bank_mask:0xf
    v_mfma_f32_16x16x32_bf16 v[36:39], a[100:103], v[24:27], v[36:39]
    ds_read_b128 v[64:67], v3 offset:49152
    v_add_f32_dpp v173, v173, v173 row_mirror row_mask:0xf bank_mask:0xf
    v_mfma_f32_16x16x32_bf16 v[40:43], a[104:107], v[24:27], v[40:43]
    ds_read_b128 v[68:71], v3 offset:50176
    v_add_f32_dpp v172, v172, v172 row_bcast:15 row_mask:0xa bank_mask:0xf
    v_mfma_f32_16x16x32_bf16 v[44:47], a[108:111], v[24:27], v[44:47]
    s_waitcnt lgkmcnt(4)
    ds_read_b128 v[72:75], v3 offset:51200
    v_add_f32_dpp v173, v173, v173 row_bcast:15 row_mask:0xa bank_mask:0xf
    v_mfma_f32_16x16x32_bf16 v[32:35], a[112:115], v[28:31], v[32:35]
    ds_read_b128 v[24:27], v106 offset:33280
    v_add_f32_dpp v172, v172, v172 row_bcast:31 row_mask:0xc bank_mask:0xf
    v_mfma_f32_16x16x32_bf16 v[36:39], a[116:119], v[28:31], v[36:39]
    ds_read_b128 v[76:79], v3 offset:52224
    v_add_f32_dpp v173, v173, v173 row_bcast:31 row_mask:0xc bank_mask:0xf
    v_mfma_f32_16x16x32_bf16 v[40:43], a[120:123], v[28:31], v[40:43]
    s_add_u32 s60, s65, 5505024
    buffer_store_dwordx4 v[244:247], v2, s[4:7], s60 offen sc1
    v_mul_f32 v172, 0x3b000000, v172
    v_mfma_f32_16x16x32_bf16 v[44:47], a[124:127], v[28:31], v[44:47]
    s_waitcnt lgkmcnt(6)
    buffer_load_dwordx4 v118, s[48:51], s18 offen offset:2048 lds
    v_mul_f32 v173, 0x3b000000, v173
    v_mfma_f32_16x16x32_bf16 v[32:35], a[128:131], v[16:19], v[32:35]
    s_add_u32 s60, s60, 917504
    ds_read_b128 v[28:31], v107 offset:33280
    v_fma_f32 v173, -v172, v172, v173
    v_mfma_f32_16x16x32_bf16 v[36:39], a[132:135], v[16:19], v[36:39]
    buffer_store_dwordx4 v[244:247], v2, s[4:7], s60 offen sc1
    v_max_f32 v173, 0, v173
    v_mfma_f32_16x16x32_bf16 v[40:43], a[136:139], v[16:19], v[40:43]
    s_waitcnt lgkmcnt(1)
    v_max3_u32 v14, v64, v65, v66
    v_max3_u32 v14, v14, v67, v68
    v_mfma_f32_16x16x32_bf16 v[44:47], a[140:143], v[16:19], v[44:47]
    s_waitcnt lgkmcnt(6)
    buffer_load_dwordx4 v119, s[48:51], s18 offen offset:3072 lds
    v_max3_u32 v14, v14, v69, v70
    v_mfma_f32_16x16x32_bf16 v[32:35], a[144:147], v[20:23], v[32:35]
    s_add_u32 s18, s18, 32768
    ds_read_b128 v[16:19], v104 offset:33536
    v_max3_u32 v14, v14, v71, v72
    v_mfma_f32_16x16x32_bf16 v[36:39], a[148:151], v[20:23], v[36:39]
    s_add_u32 m0, s19, 4096
    v_max3_u32 v14, v14, v73, v74
    v_max3_u32 v14, v14, v75, v76
    v_mfma_f32_16x16x32_bf16 v[40:43], a[152:155], v[20:23], v[40:43]
    v_max3_u32 v14, v14, v77, v78
    v_max_u32 v14, v14, v79
    v_mfma_f32_16x16x32_bf16 v[44:47], a[156:159], v[20:23], v[44:47]
    s_waitcnt lgkmcnt(3)
    buffer_load_dwordx4 v116, s[48:51], s18 offen offset:0 lds
    v_cmp_eq_u32 vcc, -1, v14
    v_mfma_f32_16x16x32_bf16 v[32:35], a[160:163], v[24:27], v[32:35]
    s_cbranch_vccnz L_slow8
L_back8:
    ds_read_b128 v[20:23], v105 offset:33536
    v_cvt_pk_bf16_f32 v174, v173, v172
    v_mfma_f32_16x16x32_bf16 v[36:39], a[164:167], v[24:27], v[36:39]
    v_lshlrev_b32 v173, 16, v174
    v_and_b32 v172, s57, v174
    v_mfma_f32_16x16x32_bf16 v[40:43], a[168:171], v[24:27], v[40:43]
    v_add_f32 v173, 0x3727c5ac, v173
    v_cvt_pk_bf16_f32 v174, v173, v173
    v_mfma_f32_16x16x32_bf16 v[44:47], a[172:175], v[24:27], v[44:47]
    s_waitcnt lgkmcnt(2)
    buffer_load_dwordx4 v117, s[48:51], s18 offen offset:1024 lds
    v_lshlrev_b32 v173, 16, v174
    v_mfma_f32_16x16x32_bf16 v[32:35], a[176:179], v[28:31], v[32:35]
    ds_read_b128 v[24:27], v106 offset:33536
    v_sqrt_f32 v173, v173
    v_mfma_f32_16x16x32_bf16 v[36:39], a[180:183], v[28:31], v[36:39]
    v_cvt_pk_bf16_f32 v174, v173, v173
    v_lshlrev_b32 v173, 16, v174
    v_mfma_f32_16x16x32_bf16 v[40:43], a[184:187], v[28:31], v[40:43]
    v_rcp_f32 v173, v173
    s_nop 0
    v_mul_f32 v172, -v172, v173
    v_mfma_f32_16x16x32_bf16 v[44:47], a[188:191], v[28:31], v[44:47]
    s_waitcnt lgkmcnt(2)
    buffer_load_dwordx4 v118, s[48:51], s18 offen offset:2048 lds
    v_readlane_b32 s72, v173, 63
    v_mfma_f32_16x16x32_bf16 v[32:35], a[192:195], v[16:19], v[32:35]
    ds_read_b128 v[28:31], v107 offset:33536
    v_readlane_b32 s73, v172, 63
    v_mfma_f32_16x16x32_bf16 v[36:39], a[196:199], v[16:19], v[36:39]
    s_nop 0
    v_mov_b32 v172, s73
    v_fma_f32 v160, v160, s72, v172
    v_mfma_f32_16x16x32_bf16 v[40:43], a[200:203], v[16:19], v[40:43]
    v_fma_f32 v161, v161, s72, v172
    v_fma_f32 v162, v162, s72, v172
    v_mfma_f32_16x16x32_bf16 v[44:47], a[204:207], v[16:19], v[44:47]
    s_waitcnt lgkmcnt(2)
    buffer_load_dwordx4 v119, s[48:51], s18 offen offset:3072 lds
    v_fma_f32 v163, v163, s72, v172
    s_barrier
    v_mfma_f32_16x16x32_bf16 v[32:35], a[208:211], v[20:23], v[32:35]
    s_add_u32 s18, s18, 32768
    ds_read_b128 v[16:19], v104 offset:49152
    v_fma_f32 v164, v164, s72, v172
    v_mfma_f32_16x16x32_bf16 v[36:39], a[212:215], v[20:23], v[36:39]
    v_fma_f32 v165, v165, s72, v172
    v_fma_f32 v166, v166, s72, v172
    v_mfma_f32_16x16x32_bf16 v[40:43], a[216:219], v[20:23], v[40:43]
    v_fma_f32 v167, v167, s72, v172
    v_fma_f32 v160, v160, v80, v88
    v_mfma_f32_16x16x32_bf16 v[44:47], a[220:223], v[20:23], v[44:47]
    s_waitcnt lgkmcnt(2)
    v_fma_f32 v161, v161, v81, v89
    v_fma_f32 v162, v162, v82, v90
    v_mfma_f32_16x16x32_bf16 v[32:35], a[224:227], v[24:27], v[32:35]
    ds_read_b128 v[20:23], v105 offset:49152
    v_fma_f32 v163, v163, v83, v91
    v_mfma_f32_16x16x32_bf16 v[36:39], a[228:231], v[24:27], v[36:39]
    v_fma_f32 v164, v164, v84, v92
    v_fma_f32 v165, v165, v85, v93
    v_mfma_f32_16x16x32_bf16 v[40:43], a[232:235], v[24:27], v[40:43]
    v_fma_f32 v166, v166, v86, v94
    v_fma_f32 v167, v167, v87, v95
    v_mfma_f32_16x16x32_bf16 v[44:47], a[236:239], v[24:27], v[44:47]
    s_waitcnt lgkmcnt(2)
    v_cvt_pk_bf16_f32 v168, v160, v161
    v_cvt_pk_bf16_f32 v169, v162, v163
    v_mfma_f32_16x16x32_bf16 v[32:35], a[240:243], v[28:31], v[32:35]
    ds_read_b128 v[24:27], v106 offset:49152
    v_cvt_pk_bf16_f32 v170, v164, v165
    v_mfma_f32_16x16x32_bf16 v[36:39], a[244:247], v[28:31], v[36:39]
    v_cvt_pk_bf16_f32 v171, v166, v167
    v_min_u32 v168, s58, v168
    v_mfma_f32_16x16x32_bf16 v[40:43], a[248:251], v[28:31], v[40:43]
    v_min_u32 v169, s58, v169
    v_min_u32 v170, s58, v170
    v_mfma_f32_16x16x32_bf16 v[44:47], a[252:255], v[28:31], v[44:47]
    s_waitcnt lgkmcnt(2)
    v_min_u32 v171, s58, v171
    buffer_store_dwordx4 v[168:171], v2, s[4:7], s66 offen sc1
    v_mfma_f32_16x16x32_bf16 v[48:51], a[0:3], v[16:19], 0
    s_add_u32 m0, s69, 16384
    ds_read_b128 v[28:31], v107 offset:49152
    s_add_u32 s63, s70, 786432
    v_mfma_f32_16x16x32_bf16 v[52:55], a[4:7], v[16:19], 0
    s_add_u32 s60, s68, 6291456
    buffer_load_dwordx4 v108, s[4:7], s63 offen offset:0 sc1 lds
    v_mfma_f32_16x16x32_bf16 v[56:59], a[8:11], v[16:19], 0
    buffer_store_dwordx4 v[176:179], v2, s[4:7], s60 offen sc1
    s_add_u32 s60, s60, 0x100000
    v_mfma_f32_16x16x32_bf16 v[60:63], a[12:15], v[16:19], 0
    s_waitcnt lgkmcnt(2)
    buffer_store_dwordx4 v[188:191], v2, s[4:7], s60 offen sc1
    v_mul_f32 v32, v32, v40
    v_mfma_f32_16x16x32_bf16 v[48:51], a[16:19], v[20:23], v[48:51]
    ds_read_b128 v[16:19], v104 offset:49408
    v_mul_f32 v33, v33, v41
    v_mfma_f32_16x16x32_bf16 v[52:55], a[20:23], v[20:23], v[52:55]
    buffer_load_dwordx4 v109, s[4:7], s63 offen offset:1024 sc1 lds
    v_mul_f32 v34, v34, v42
    v_mfma_f32_16x16x32_bf16 v[56:59], a[24:27], v[20:23], v[56:59]
    v_mul_f32 v35, v35, v43
    v_mul_f32 v36, v36, v44
    v_mfma_f32_16x16x32_bf16 v[60:63], a[28:31], v[20:23], v[60:63]
    s_waitcnt lgkmcnt(2)
    v_mul_f32 v37, v37, v45
    v_mul_f32 v38, v38, v46
    v_mfma_f32_16x16x32_bf16 v[48:51], a[32:35], v[24:27], v[48:51]
    ds_read_b128 v[20:23], v105 offset:49408
    v_mul_f32 v39, v39, v47
    v_mfma_f32_16x16x32_bf16 v[52:55], a[36:39], v[24:27], v[52:55]
    buffer_load_dwordx4 v110, s[4:7], s63 offen offset:2048 sc1 lds
    v_cvt_pk_bf16_f32 v112, v32, v33
    v_mfma_f32_16x16x32_bf16 v[56:59], a[40:43], v[24:27], v[56:59]
    v_cvt_pk_bf16_f32 v113, v34, v35
    v_cvt_pk_bf16_f32 v114, v36, v37
    v_mfma_f32_16x16x32_bf16 v[60:63], a[44:47], v[24:27], v[60:63]
    s_waitcnt lgkmcnt(2)
    v_cvt_pk_bf16_f32 v115, v38, v39
    v_mfma_f32_16x16x32_bf16 v[48:51], a[48:51], v[28:31], v[48:51]
    ds_read_b128 v[24:27], v106 offset:49408
    v_mfma_f32_16x16x32_bf16 v[52:55], a[52:55], v[28:31], v[52:55]
    buffer_store_dwordx4 v[112:115], v2, s[4:7], s65 offen sc1
    s_add_u32 s65, s65, 917504
    v_mfma_f32_16x16x32_bf16 v[56:59], a[56:59], v[28:31], v[56:59]
    buffer_load_dwordx4 v111, s[4:7], s63 offen offset:3072 sc1 lds
    s_add_u32 m0, s19, 8192
    v_mfma_f32_16x16x32_bf16 v[60:63], a[60:63], v[28:31], v[60:63]
    s_waitcnt lgkmcnt(2)
    v_mfma_f32_16x16x32_bf16 v[48:51], a[64:67], v[16:19], v[48:51]
    ds_read_b128 v[28:31], v107 offset:49408
    v_mfma_f32_16x16x32_bf16 v[52:55], a[68:71], v[16:19], v[52:55]
    v_mfma_f32_16x16x32_bf16 v[56:59], a[72:75], v[16:19], v[56:59]
    buffer_load_dwordx4 v116, s[48:51], s18 offen offset:0 lds
    v_mfma_f32_16x16x32_bf16 v[60:63], a[76:79], v[16:19], v[60:63]
    s_waitcnt lgkmcnt(2)
    v_mfma_f32_16x16x32_bf16 v[48:51], a[80:83], v[20:23], v[48:51]
    ds_read_b128 v[16:19], v104 offset:49664
    v_mfma_f32_16x16x32_bf16 v[52:55], a[84:87], v[20:23], v[52:55]
    v_mfma_f32_16x16x32_bf16 v[56:59], a[88:91], v[20:23], v[56:59]
    buffer_load_dwordx4 v117, s[48:51], s18 offen offset:1024 lds
    v_mfma_f32_16x16x32_bf16 v[60:63], a[92:95], v[20:23], v[60:63]
    s_waitcnt lgkmcnt(2)
    v_mfma_f32_16x16x32_bf16 v[48:51], a[96:99], v[24:27], v[48:51]
    s_waitcnt vmcnt(20)
    ds_read_b128 v[20:23], v105 offset:49664
    v_mfma_f32_16x16x32_bf16 v[52:55], a[100:103], v[24:27], v[52:55]
    ds_read_b128 v[64:67], v3 offset:0
    v_mfma_f32_16x16x32_bf16 v[56:59], a[104:107], v[24:27], v[56:59]
    ds_read_b128 v[68:71], v3 offset:1024
    v_mfma_f32_16x16x32_bf16 v[60:63], a[108:111], v[24:27], v[60:63]
    s_waitcnt lgkmcnt(4)
    ds_read_b128 v[72:75], v3 offset:2048
    v_mfma_f32_16x16x32_bf16 v[48:51], a[112:115], v[28:31], v[48:51]
    ds_read_b128 v[24:27], v106 offset:49664
    v_mfma_f32_16x16x32_bf16 v[52:55], a[116:119], v[28:31], v[52:55]
    ds_read_b128 v[76:79], v3 offset:3072
    v_mfma_f32_16x16x32_bf16 v[56:59], a[120:123], v[28:31], v[56:59]
    buffer_load_dwordx4 v118, s[48:51], s18 offen offset:2048 lds
    v_mfma_f32_16x16x32_bf16 v[60:63], a[124:127], v[28:31], v[60:63]
    s_waitcnt lgkmcnt(6)
    v_mfma_f32_16x16x32_bf16 v[48:51], a[128:131], v[16:19], v[48:51]
    ds_read_b128 v[28:31], v107 offset:49664
    v_mfma_f32_16x16x32_bf16 v[52:55], a[132:135], v[16:19], v[52:55]
    v_mfma_f32_16x16x32_bf16 v[56:59], a[136:139], v[16:19], v[56:59]
    s_waitcnt lgkmcnt(1)
    buffer_load_dwordx4 v119, s[48:51], s18 offen offset:3072 lds
    v_max3_u32 v14, v64, v65, v66
    v_mfma_f32_16x16x32_bf16 v[60:63], a[140:143], v[16:19], v[60:63]
    s_waitcnt lgkmcnt(6)
    v_max3_u32 v14, v14, v67, v68
    v_max3_u32 v14, v14, v69, v70
    v_mfma_f32_16x16x32_bf16 v[48:51], a[144:147], v[20:23], v[48:51]
    s_add_u32 s18, s18, 32768
    ds_read_b128 v[16:19], v104 offset:49920
    v_max3_u32 v14, v14, v71, v72
    v_mfma_f32_16x16x32_bf16 v[52:55], a[148:151], v[20:23], v[52:55]
    s_add_u32 m0, s19, 12288
    v_max3_u32 v14, v14, v73, v74
    v_max3_u32 v14, v14, v75, v76
    v_mfma_f32_16x16x32_bf16 v[56:59], a[152:155], v[20:23], v[56:59]
    buffer_load_dwordx4 v116, s[48:51], s18 offen offset:0 lds
    v_max3_u32 v14, v14, v77, v78
    v_mfma_f32_16x16x32_bf16 v[60:63], a[156:159], v[20:23], v[60:63]
    s_waitcnt lgkmcnt(3)
    v_max_u32 v14, v14, v79
    v_cmp_eq_u32 vcc, -1, v14
    v_mfma_f32_16x16x32_bf16 v[48:51], a[160:163], v[24:27], v[48:51]
    s_cbranch_vccnz L_slow9
L_back9:
    ds_read_b128 v[20:23], v105 offset:49920
    v_mfma_f32_16x16x32_bf16 v[52:55], a[164:167], v[24:27], v[52:55]
    v_mfma_f32_16x16x32_bf16 v[56:59], a[168:171], v[24:27], v[56:59]
    buffer_load_dwordx4 v117, s[48:51], s18 offen offset:1024 lds
    v_mfma_f32_16x16x32_bf16 v[60:63], a[172:175], v[24:27], v[60:63]
    s_waitcnt lgkmcnt(2)
    v_mfma_f32_16x16x32_bf16 v[48:51], a[176:179], v[28:31], v[48:51]
    ds_read_b128 v[24:27], v106 offset:49920
    v_mfma_f32_16x16x32_bf16 v[52:55], a[180:183], v[28:31], v[52:55]
    v_mfma_f32_16x16x32_bf16 v[56:59], a[184:187], v[28:31], v[56:59]
    buffer_load_dwordx4 v118, s[48:51], s18 offen offset:2048 lds
    v_mfma_f32_16x16x32_bf16 v[60:63], a[188:191], v[28:31], v[60:63]
    s_waitcnt lgkmcnt(2)
    v_mfma_f32_16x16x32_bf16 v[48:51], a[192:195], v[16:19], v[48:51]
    ds_read_b128 v[28:31], v107 offset:49920
    v_mfma_f32_16x16x32_bf16 v[52:55], a[196:199], v[16:19], v[52:55]
    v_mfma_f32_16x16x32_bf16 v[56:59], a[200:203], v[16:19], v[56:59]
    buffer_load_dwordx4 v119, s[48:51], s18 offen offset:3072 lds
    s_add_u32 s18, s18, 32768
    v_mfma_f32_16x16x32_bf16 v[60:63], a[204:207], v[16:19], v[60:63]
    s_waitcnt lgkmcnt(2)
    s_barrier
    v_mfma_f32_16x16x32_bf16 v[48:51], a[208:211], v[20:23], v[48:51]
    ds_read_b128 v[16:19], v104 offset:0
    v_mfma_f32_16x16x32_bf16 v[52:55], a[212:215], v[20:23], v[52:55]
    v_mfma_f32_16x16x32_bf16 v[56:59], a[216:219], v[20:23], v[56:59]
    v_mfma_f32_16x16x32_bf16 v[60:63], a[220:223], v[20:23], v[60:63]
    s_waitcnt lgkmcnt(2)
    v_mfma_f32_16x16x32_bf16 v[48:51], a[224:227], v[24:27], v[48:51]
    ds_read_b128 v[20:23], v105 offset:0
    v_mfma_f32_16x16x32_bf16 v[52:55], a[228:231], v[24:27], v[52:55]
    v_mfma_f32_16x16x32_bf16 v[56:59], a[232:235], v[24:27], v[56:59]
    v_mfma_f32_16x16x32_bf16 v[60:63], a[236:239], v[24:27], v[60:63]
    s_waitcnt lgkmcnt(2)
    v_mfma_f32_16x16x32_bf16 v[48:51], a[240:243], v[28:31], v[48:51]
    ds_read_b128 v[24:27], v106 offset:0
    v_mfma_f32_16x16x32_bf16 v[52:55], a[244:247], v[28:31], v[52:55]
    v_mfma_f32_16x16x32_bf16 v[56:59], a[248:251], v[28:31], v[56:59]
    v_mfma_f32_16x16x32_bf16 v[60:63], a[252:255], v[28:31], v[60:63]
    s_waitcnt lgkmcnt(2)
    v_mfma_f32_16x16x32_bf16 v[32:35], a[0:3], v[16:19], 0
    s_add_u32 m0, s19, 16384
    ds_read_b128 v[28:31], v107 offset:0
    s_waitcnt vmcnt(16)
    v_mfma_f32_16x16x32_bf16 v[36:39], a[4:7], v[16:19], 0
    buffer_load_dwordx4 v116, s[48:51], s18 offen offset:0 lds
    v_mfma_f32_16x16x32_bf16 v[40:43], a[8:11], v[16:19], 0
    ds_read_b64_tr_b16 v[128:129], v124 offset:0
    v_mfma_f32_16x16x32_bf16 v[44:47], a[12:15], v[16:19], 0
    s_waitcnt lgkmcnt(3)
    ds_read_b64_tr_b16 v[130:131], v124 offset:2048
    v_mul_f32 v48, v48, v56
    v_mfma_f32_16x16x32_bf16 v[32:35], a[16:19], v[20:23], v[32:35]
    ds_read_b128 v[16:19], v104 offset:256
    v_mul_f32 v49, v49, v57
    v_mfma_f32_16x16x32_bf16 v[36:39], a[20:23], v[20:23], v[36:39]
    buffer_load_dwordx4 v117, s[48:51], s18 offen offset:1024 lds
    v_mul_f32 v50, v50, v58
    v_mfma_f32_16x16x32_bf16 v[40:43], a[24:27], v[20:23], v[40:43]
    ds_read_b64_tr_b16 v[132:133], v125 offset:0
    v_mul_f32 v51, v51, v59
    v_mfma_f32_16x16x32_bf16 v[44:47], a[28:31], v[20:23], v[44:47]
    s_waitcnt lgkmcnt(5)
    ds_read_b64_tr_b16 v[134:135], v125 offset:2048
    v_mul_f32 v52, v52, v60
    v_mfma_f32_16x16x32_bf16 v[32:35], a[32:35], v[24:27], v[32:35]
    ds_read_b128 v[20:23], v105 offset:256
    v_mul_f32 v53, v53, v61
    v_mfma_f32_16x16x32_bf16 v[36:39], a[36:39], v[24:27], v[36:39]
    buffer_load_dwordx4 v118, s[48:51], s18 offen offset:2048 lds
    v_mul_f32 v54, v54, v62
    v_mfma_f32_16x16x32_bf16 v[40:43], a[40:43], v[24:27], v[40:43]
    ds_read_b64_tr_b16 v[136:137], v126 offset:0
    v_mul_f32 v55, v55, v63
    v_mfma_f32_16x16x32_bf16 v[44:47], a[44:47], v[24:27], v[44:47]
    s_waitcnt lgkmcnt(7)
    ds_read_b64_tr_b16 v[138:139], v126 offset:2048
    v_cvt_pk_bf16_f32 v112, v48, v49
    v_mfma_f32_16x16x32_bf16 v[32:35], a[48:51], v[28:31], v[32:35]
    ds_read_b128 v[24:27], v106 offset:256
    v_cvt_pk_bf16_f32 v113, v50, v51
    v_mfma_f32_16x16x32_bf16 v[36:39], a[52:55], v[28:31], v[36:39]
    buffer_load_dwordx4 v119, s[48:51], s18 offen offset:3072 lds
    v_cvt_pk_bf16_f32 v114, v52, v53
    v_mfma_f32_16x16x32_bf16 v[40:43], a[56:59], v[28:31], v[40:43]
    s_add_u32 s18, s18, 32768
    ds_read_b64_tr_b16 v[140:141], v127 offset:0
    v_cvt_pk_bf16_f32 v115, v54, v55
    v_mfma_f32_16x16x32_bf16 v[44:47], a[60:63], v[28:31], v[44:47]
    s_waitcnt lgkmcnt(7)
    buffer_store_dwordx4 v[112:115], v2, s[4:7], s65 offen sc1
    s_add_u32 s65, s65, 917504
    v_mfma_f32_16x16x32_bf16 v[32:35], a[64:67], v[16:19], v[32:35]
    s_add_u32 m0, s19, 20480
    ds_read_b128 v[28:31], v107 offset:256
    v_mfma_f32_16x16x32_bf16 v[36:39], a[68:71], v[16:19], v[36:39]
    buffer_load_dwordx4 v116, s[48:51], s18 offen offset:0 lds
    v_mfma_f32_16x16x32_bf16 v[40:43], a[72:75], v[16:19], v[40:43]
    ds_read_b64_tr_b16 v[142:143], v127 offset:2048
    v_mfma_f32_16x16x32_bf16 v[44:47], a[76:79], v[16:19], v[44:47]
    s_waitcnt lgkmcnt(6)
    ds_read_b64_tr_b16 v[144:145], v124 offset:4096
    v_mfma_f32_16x16x32_bf16 v[32:35], a[80:83], v[20:23], v[32:35]
    ds_read_b128 v[16:19], v104 offset:512
    v_mfma_f32_16x16x32_bf16 v[36:39], a[84:87], v[20:23], v[36:39]
    buffer_load_dwordx4 v117, s[48:51], s18 offen offset:1024 lds
    v_mfma_f32_16x16x32_bf16 v[40:43], a[88:91], v[20:23], v[40:43]
    ds_read_b64_tr_b16 v[146:147], v124 offset:6144
    v_mfma_f32_16x16x32_bf16 v[44:47], a[92:95], v[20:23], v[44:47]
    s_waitcnt lgkmcnt(6)
    ds_read_b64_tr_b16 v[148:149], v125 offset:4096
    v_mfma_f32_16x16x32_bf16 v[32:35], a[96:99], v[24:27], v[32:35]
    s_waitcnt vmcnt(15)
    ds_read_b128 v[20:23], v105 offset:512
    v_mfma_f32_16x16x32_bf16 v[36:39], a[100:103], v[24:27], v[36:39]
    ds_read_b128 v[64:67], v3 offset:16384
    v_mfma_f32_16x16x32_bf16 v[40:43], a[104:107], v[24:27], v[40:43]
    ds_read_b128 v[68:71], v3 offset:17408
    v_mfma_f32_16x16x32_bf16 v[44:47], a[108:111], v[24:27], v[44:47]
    s_waitcnt lgkmcnt(8)
    ds_read_b128 v[72:75], v3 offset:18432
    v_mfma_f32_16x16x32_bf16 v[32:35], a[112:115], v[28:31], v[32:35]
    ds_read_b128 v[24:27], v106 offset:512
    v_mfma_f32_16x16x32_bf16 v[36:39], a[116:119], v[28:31], v[36:39]
    ds_read_b128 v[76:79], v3 offset:19456
    v_mfma_f32_16x16x32_bf16 v[40:43], a[120:123], v[28:31], v[40:43]
    buffer_load_dwordx4 v118, s[48:51], s18 offen offset:2048 lds
    v_mfma_f32_16x16x32_bf16 v[44:47], a[124:127], v[28:31], v[44:47]
    s_waitcnt lgkmcnt(8)
    ds_read_b64_tr_b16 v[150:151], v125 offset:6144
    v_mfma_f32_16x16x32_bf16 v[32:35], a[128:131], v[16:19], v[32:35]
    ds_read_b128 v[28:31], v107 offset:512
    v_mfma_f32_16x16x32_bf16 v[36:39], a[132:135], v[16:19], v[36:39]
    ds_read_b64_tr_b16 v[152:153], v126 offset:4096
    v_mfma_f32_16x16x32_bf16 v[40:43], a[136:139], v[16:19], v[40:43]
    s_waitcnt lgkmcnt(3)
    buffer_load_dwordx4 v119, s[48:51], s18 offen offset:3072 lds
    v_max3_u32 v14, v64, v65, v66
    v_mfma_f32_16x16x32_bf16 v[44:47], a[140:143], v[16:19], v[44:47]
    s_waitcnt lgkmcnt(8)
    ds_read_b64_tr_b16 v[154:155], v126 offset:6144
    v_max3_u32 v14, v14, v67, v68
    v_mfma_f32_16x16x32_bf16 v[32:35], a[144:147], v[20:23], v[32:35]
    s_add_u32 s18, s18, 32768
    ds_read_b128 v[16:19], v104 offset:768
    v_max3_u32 v14, v14, v69, v70
    v_mfma_f32_16x16x32_bf16 v[36:39], a[148:151], v[20:23], v[36:39]
    s_add_u32 m0, s69, 32768
    ds_read_b64_tr_b16 v[156:157], v127 offset:4096
    v_max3_u32 v14, v14, v71, v72
    v_mfma_f32_16x16x32_bf16 v[40:43], a[152:155], v[20:23], v[40:43]
    s_add_u32 s63, s70, 1048576
    buffer_load_dwordx4 v108, s[4:7], s63 offen offset:0 sc1 lds
    v_max3_u32 v14, v14, v73, v74
    v_mfma_f32_16x16x32_bf16 v[44:47], a[156:159], v[20:23], v[44:47]
    s_waitcnt lgkmcnt(7)
    ds_read_b64_tr_b16 v[158:159], v127 offset:6144
    v_max3_u32 v14, v14, v75, v76
    v_mfma_f32_16x16x32_bf16 v[32:35], a[160:163], v[24:27], v[32:35]
    ds_read_b128 v[20:23], v105 offset:768
    v_max3_u32 v14, v14, v77, v78
    v_mfma_f32_16x16x32_bf16 v[36:39], a[164:167], v[24:27], v[36:39]
    v_max_u32 v14, v14, v79
    v_cmp_eq_u32 vcc, -1, v14
    v_mfma_f32_16x16x32_bf16 v[40:43], a[168:171], v[24:27], v[40:43]
    s_cbranch_vccnz L_slow10
L_back10:
    buffer_load_dwordx4 v109, s[4:7], s63 offen offset:1024 sc1 lds
    v_mfma_f32_16x16x32_bf16 v[44:47], a[172:175], v[24:27], v[44:47]
    s_waitcnt lgkmcnt(6)
    v_mfma_f32_16x16x32_bf16 v[32:35], a[176:179], v[28:31], v[32:35]
    ds_read_b128 v[24:27], v106 offset:768
    v_mfma_f32_16x16x32_bf16 v[36:39], a[180:183], v[28:31], v[36:39]
    v_mfma_f32_16x16x32_bf16 v[40:43], a[184:187], v[28:31], v[40:43]
    buffer_load_dwordx4 v110, s[4:7], s63 offen offset:2048 sc1 lds
    v_mfma_f32_16x16x32_bf16 v[44:47], a[188:191], v[28:31], v[44:47]
    s_waitcnt lgkmcnt(4)
    v_mfma_f32_16x16x32_bf16 v[32:35], a[192:195], v[16:19], v[32:35]
    ds_read_b128 v[28:31], v107 offset:768
    v_mfma_f32_16x16x32_bf16 v[36:39], a[196:199], v[16:19], v[36:39]
    v_mfma_f32_16x16x32_bf16 v[40:43], a[200:203], v[16:19], v[40:43]
    buffer_load_dwordx4 v111, s[4:7], s63 offen offset:3072 sc1 lds
    v_mfma_f32_16x16x32_bf16 v[44:47], a[204:207], v[16:19], v[44:47]
    s_waitcnt lgkmcnt(2)
    s_waitcnt vmcnt(25)
    s_barrier
    v_mfma_f32_16x16x32_bf16 v[32:35], a[208:211], v[20:23], v[32:35]
    s_waitcnt vmcnt(8)
    ds_read_b128 v[16:19], v104 offset:16384
    s_add_u32 s60, s61, 17563648
    v_mfma_f32_16x16x32_bf16 v[36:39], a[212:215], v[20:23], v[36:39]
    v_lshlrev_b32 v7, 26, v6
    v_lshl_add_u32 v7, v5, 2, v7
    v_mfma_f32_16x16x32_bf16 v[40:43], a[216:219], v[20:23], v[40:43]
    v_mov_b32 v8, s56
    v_mfma_f32_16x16x32_bf16 v[44:47], a[220:223], v[20:23], v[44:47]
    s_waitcnt lgkmcnt(2)
    buffer_store_dword v8, v7, s[4:7], s60 offen sc1
    s_add_u32 s60, s64, 17104896
    v_mfma_f32_16x16x32_bf16 v[32:35], a[224:227], v[24:27], v[32:35]
    ds_read_b128 v[20:23], v105 offset:16384
    v_lshlrev_b32 v7, 26, v6
    v_mfma_f32_16x16x32_bf16 v[36:39], a[228:231], v[24:27], v[36:39]
    v_lshl_add_u32 v7, v5, 2, v7
    v_mov_b32 v8, s56
    v_mfma_f32_16x16x32_bf16 v[40:43], a[232:235], v[24:27], v[40:43]
    buffer_store_dword v8, v7, s[4:7], s60 offen sc1
    v_mfma_f32_16x16x32_bf16 v[44:47], a[236:239], v[24:27], v[44:47]
    s_waitcnt lgkmcnt(2)
    v_mfma_f32_16x16x32_bf16 v[32:35], a[240:243], v[28:31], v[32:35]
    ds_read_b128 v[24:27], v106 offset:16384
    v_mfma_f32_16x16x32_bf16 v[36:39], a[244:247], v[28:31], v[36:39]
    v_mfma_f32_16x16x32_bf16 v[40:43], a[248:251], v[28:31], v[40:43]
    v_mfma_f32_16x16x32_bf16 v[44:47], a[252:255], v[28:31], v[44:47]
    s_waitcnt lgkmcnt(2)
    v_mfma_f32_16x16x32_bf16 v[48:51], a[0:3], v[16:19], 0
    s_add_u32 m0, s69, 49152
    ds_read_b128 v[28:31], v107 offset:16384
    s_add_u32 s63, s70, 1310720
    v_mfma_f32_16x16x32_bf16 v[52:55], a[4:7], v[16:19], 0
    s_waitcnt vmcnt(15)
    buffer_load_dwordx4 v108, s[4:7], s63 offen offset:0 sc1 lds
    v_mfma_f32_16x16x32_bf16 v[56:59], a[8:11], v[16:19], 0
    ds_read_b64_tr_b16 v[160:161], v124 offset:8192
    v_mfma_f32_16x16x32_bf16 v[60:63], a[12:15], v[16:19], 0
    s_waitcnt lgkmcnt(3)
    ds_read_b64_tr_b16 v[162:163], v124 offset:10240
    v_mul_f32 v32, v32, v40
    v_mfma_f32_16x16x32_bf16 v[48:51], a[16:19], v[20:23], v[48:51]
    ds_read_b128 v[16:19], v104 offset:16640
    v_mul_f32 v33, v33, v41
    v_mfma_f32_16x16x32_bf16 v[52:55], a[20:23], v[20:23], v[52:55]
    buffer_load_dwordx4 v109, s[4:7], s63 offen offset:1024 sc1 lds
    v_mul_f32 v34, v34, v42
    v_mfma_f32_16x16x32_bf16 v[56:59], a[24:27], v[20:23], v[56:59]
    ds_read_b64_tr_b16 v[164:165], v125 offset:8192
    v_mul_f32 v35, v35, v43
    v_mfma_f32_16x16x32_bf16 v[60:63], a[28:31], v[20:23], v[60:63]
    s_waitcnt lgkmcnt(5)
    ds_read_b64_tr_b16 v[166:167], v125 offset:10240
    v_mul_f32 v36, v36, v44
    v_mfma_f32_16x16x32_bf16 v[48:51], a[32:35], v[24:27], v[48:51]
    ds_read_b128 v[20:23], v105 offset:16640
    v_mul_f32 v37, v37, v45
    v_mfma_f32_16x16x32_bf16 v[52:55], a[36:39], v[24:27], v[52:55]
    buffer_load_dwordx4 v110, s[4:7], s63 offen offset:2048 sc1 lds
    v_mul_f32 v38, v38, v46
    v_mfma_f32_16x16x32_bf16 v[56:59], a[40:43], v[24:27], v[56:59]
    ds_read_b64_tr_b16 v[168:169], v126 offset:8192
    v_mul_f32 v39, v39, v47
    v_mfma_f32_16x16x32_bf16 v[60:63], a[44:47], v[24:27], v[60:63]
    s_waitcnt lgkmcnt(7)
    ds_read_b64_tr_b16 v[170:171], v126 offset:10240
    v_cvt_pk_bf16_f32 v112, v32, v33
    v_mfma_f32_16x16x32_bf16 v[48:51], a[48:51], v[28:31], v[48:51]
    ds_read_b128 v[24:27], v106 offset:16640
    v_cvt_pk_bf16_f32 v113, v34, v35
    v_mfma_f32_16x16x32_bf16 v[52:55], a[52:55], v[28:31], v[52:55]
    buffer_load_dwordx4 v111, s[4:7], s63 offen offset:3072 sc1 lds
    v_cvt_pk_bf16_f32 v114, v36, v37
    v_mfma_f32_16x16x32_bf16 v[56:59], a[56:59], v[28:31], v[56:59]
    s_waitcnt lgkmcnt(15)
    ds_read_b64_tr_b16 v[172:173], v127 offset:8192
    v_cvt_pk_bf16_f32 v115, v38, v39
    v_mfma_f32_16x16x32_bf16 v[60:63], a[60:63], v[28:31], v[60:63]
    s_waitcnt lgkmcnt(7)
    buffer_store_dwordx4 v[112:115], v2, s[4:7], s65 offen sc1
    s_add_u32 s65, s65, 917504
    v_mfma_f32_16x16x32_bf16 v[48:51], a[64:67], v[16:19], v[48:51]
    s_add_u32 m0, s19, 0
    ds_read_b128 v[28:31], v107 offset:16640
    v_mfma_f32_16x16x32_bf16 v[52:55], a[68:71], v[16:19], v[52:55]
    buffer_load_dwordx4 v116, s[48:51], s18 offen offset:0 lds
    v_mfma_f32_16x16x32_bf16 v[56:59], a[72:75], v[16:19], v[56:59]
    ds_read_b64_tr_b16 v[174:175], v127 offset:10240
    v_mfma_f32_16x16x32_bf16 v[60:63], a[76:79], v[16:19], v[60:63]
    s_waitcnt lgkmcnt(6)
    ds_read_b64_tr_b16 v[176:177], v124 offset:12288
    v_mfma_f32_16x16x32_bf16 v[48:51], a[80:83], v[20:23], v[48:51]
    ds_read_b128 v[16:19], v104 offset:16896
    v_mfma_f32_16x16x32_bf16 v[52:55], a[84:87], v[20:23], v[52:55]
    buffer_load_dwordx4 v117, s[48:51], s18 offen offset:1024 lds
    v_mfma_f32_16x16x32_bf16 v[56:59], a[88:91], v[20:23], v[56:59]
    ds_read_b64_tr_b16 v[178:179], v124 offset:14336
    v_mfma_f32_16x16x32_bf16 v[60:63], a[92:95], v[20:23], v[60:63]
    s_waitcnt lgkmcnt(6)
    ds_read_b64_tr_b16 v[180:181], v125 offset:12288
    v_mfma_f32_16x16x32_bf16 v[48:51], a[96:99], v[24:27], v[48:51]
    ds_read_b128 v[20:23], v105 offset:16896
    v_mfma_f32_16x16x32_bf16 v[52:55], a[100:103], v[24:27], v[52:55]
    buffer_load_dwordx4 v118, s[48:51], s18 offen offset:2048 lds
    v_mfma_f32_16x16x32_bf16 v[56:59], a[104:107], v[24:27], v[56:59]
    ds_read_b64_tr_b16 v[182:183], v125 offset:14336
    v_mfma_f32_16x16x32_bf16 v[60:63], a[108:111], v[24:27], v[60:63]
    s_waitcnt lgkmcnt(7)
    ds_read_b64_tr_b16 v[184:185], v126 offset:12288
    v_mfma_f32_16x16x32_bf16 v[48:51], a[112:115], v[28:31], v[48:51]
    ds_read_b128 v[24:27], v106 offset:16896
    v_mfma_f32_16x16x32_bf16 v[52:55], a[116:119], v[28:31], v[52:55]
    buffer_load_dwordx4 v119, s[48:51], s18 offen offset:3072 lds
    s_add_u32 s18, s18, 32768
    v_mfma_f32_16x16x32_bf16 v[56:59], a[120:123], v[28:31], v[56:59]
    s_add_u32 m0, s19, 4096
    ds_read_b64_tr_b16 v[186:187], v126 offset:14336
    v_mfma_f32_16x16x32_bf16 v[60:63], a[124:127], v[28:31], v[60:63]
    s_waitcnt lgkmcnt(7)
    ds_read_b64_tr_b16 v[188:189], v127 offset:12288
    v_mfma_f32_16x16x32_bf16 v[48:51], a[128:131], v[16:19], v[48:51]
    s_waitcnt vmcnt(11)
    ds_read_b128 v[28:31], v107 offset:16896
    v_mfma_f32_16x16x32_bf16 v[52:55], a[132:135], v[16:19], v[52:55]
    ds_read_b128 v[64:67], v3 offset:32768
    v_mfma_f32_16x16x32_bf16 v[56:59], a[136:139], v[16:19], v[56:59]
    ds_read_b128 v[68:71], v3 offset:33792
    v_mfma_f32_16x16x32_bf16 v[60:63], a[140:143], v[16:19], v[60:63]
    s_waitcnt lgkmcnt(8)
    ds_read_b128 v[72:75], v3 offset:34816
    v_mfma_f32_16x16x32_bf16 v[48:51], a[144:147], v[20:23], v[48:51]
    ds_read_b128 v[16:19], v104 offset:17152
    v_mfma_f32_16x16x32_bf16 v[52:55], a[148:151], v[20:23], v[52:55]
    ds_read_b128 v[76:79], v3 offset:35840
    v_mfma_f32_16x16x32_bf16 v[56:59], a[152:155], v[20:23], v[56:59]
    buffer_load_dwordx4 v116, s[48:51], s18 offen offset:0 lds
    v_mfma_f32_16x16x32_bf16 v[60:63], a[156:159], v[20:23], v[60:63]
    s_waitcnt lgkmcnt(8)
    ds_read_b64_tr_b16 v[190:191], v127 offset:14336
    v_mfma_f32_16x16x32_bf16 v[48:51], a[160:163], v[24:27], v[48:51]
    ds_read_b128 v[20:23], v105 offset:17152
    v_mfma_f32_16x16x32_bf16 v[52:55], a[164:167], v[24:27], v[52:55]
    v_mfma_f32_16x16x32_bf16 v[56:59], a[168:171], v[24:27], v[56:59]
    s_waitcnt lgkmcnt(2)
    buffer_load_dwordx4 v117, s[48:51], s18 offen offset:1024 lds
    v_max3_u32 v14, v64, v65, v66
    v_mfma_f32_16x16x32_bf16 v[60:63], a[172:175], v[24:27], v[60:63]
    s_waitcnt lgkmcnt(7)
    v_max3_u32 v14, v14, v67, v68
    v_max3_u32 v14, v14, v69, v70
    v_mfma_f32_16x16x32_bf16 v[48:51], a[176:179], v[28:31], v[48:51]
    ds_read_b128 v[24:27], v106 offset:17152
    v_max3_u32 v14, v14, v71, v72
    v_mfma_f32_16x16x32_bf16 v[52:55], a[180:183], v[28:31], v[52:55]
    v_max3_u32 v14, v14, v73, v74
    v_max3_u32 v14, v14, v75, v76
    v_mfma_f32_16x16x32_bf16 v[56:59], a[184:187], v[28:31], v[56:59]
    buffer_load_dwordx4 v118, s[48:51], s18 offen offset:2048 lds
    v_max3_u32 v14, v14, v77, v78
    v_mfma_f32_16x16x32_bf16 v[60:63], a[188:191], v[28:31], v[60:63]
    s_waitcnt lgkmcnt(4)
    v_max_u32 v14, v14, v79
    v_cmp_eq_u32 vcc, -1, v14
    v_mfma_f32_16x16x32_bf16 v[48:51], a[192:195], v[16:19], v[48:51]
    s_cbranch_vccnz L_slow11
L_back11:
    ds_read_b128 v[28:31], v107 offset:17152
    v_mfma_f32_16x16x32_bf16 v[52:55], a[196:199], v[16:19], v[52:55]
    v_mfma_f32_16x16x32_bf16 v[56:59], a[200:203], v[16:19], v[56:59]
    buffer_load_dwordx4 v119, s[48:51], s18 offen offset:3072 lds
    s_add_u32 s18, s18, 32768
    v_mfma_f32_16x16x32_bf16 v[60:63], a[204:207], v[16:19], v[60:63]
    s_waitcnt lgkmcnt(2)
    s_barrier
    v_mfma_f32_16x16x32_bf16 v[48:51], a[208:211], v[20:23], v[48:51]
    ds_read_b128 v[16:19], v104 offset:32768
    v_mfma_f32_16x16x32_bf16 v[52:55], a[212:215], v[20:23], v[52:55]
    v_mfma_f32_16x16x32_bf16 v[56:59], a[216:219], v[20:23], v[56:59]
    v_mfma_f32_16x16x32_bf16 v[60:63], a[220:223], v[20:23], v[60:63]
    s_waitcnt lgkmcnt(2)
    v_mfma_f32_16x16x32_bf16 v[48:51], a[224:227], v[24:27], v[48:51]
    ds_read_b128 v[20:23], v105 offset:32768
    v_mfma_f32_16x16x32_bf16 v[52:55], a[228:231], v[24:27], v[52:55]
    v_mfma_f32_16x16x32_bf16 v[56:59], a[232:235], v[24:27], v[56:59]
    v_mfma_f32_16x16x32_bf16 v[60:63], a[236:239], v[24:27], v[60:63]
    s_waitcnt lgkmcnt(2)
    v_mfma_f32_16x16x32_bf16 v[48:51], a[240:243], v[28:31], v[48:51]
    ds_read_b128 v[24:27], v106 offset:32768
    v_mfma_f32_16x16x32_bf16 v[52:55], a[244:247], v[28:31], v[52:55]
    v_mfma_f32_16x16x32_bf16 v[56:59], a[248:251], v[28:31], v[56:59]
    v_mfma_f32_16x16x32_bf16 v[60:63], a[252:255], v[28:31], v[60:63]
    s_waitcnt lgkmcnt(2)
    v_mfma_f32_16x16x32_bf16 v[32:35], a[0:3], v[16:19], 0
    s_add_u32 m0, s69, 0
    ds_read_b128 v[28:31], v107 offset:32768
    s_add_u32 s63, s70, 1572864
    v_mfma_f32_16x16x32_bf16 v[36:39], a[4:7], v[16:19], 0
    s_waitcnt vmcnt(19)
    buffer_load_dwordx4 v108, s[4:7], s63 offen offset:0 sc1 lds
    v_mfma_f32_16x16x32_bf16 v[40:43], a[8:11], v[16:19], 0
    ds_read_b64_tr_b16 v[192:193], v124 offset:16384
    v_mfma_f32_16x16x32_bf16 v[44:47], a[12:15], v[16:19], 0
    s_waitcnt lgkmcnt(3)
    ds_read_b64_tr_b16 v[194:195], v124 offset:18432
    v_mul_f32 v48, v48, v56
    v_mfma_f32_16x16x32_bf16 v[32:35], a[16:19], v[20:23], v[32:35]
    ds_read_b128 v[16:19], v104 offset:33024
    v_mul_f32 v49, v49, v57
    v_mfma_f32_16x16x32_bf16 v[36:39], a[20:23], v[20:23], v[36:39]
    buffer_load_dwordx4 v109, s[4:7], s63 offen offset:1024 sc1 lds
    v_mul_f32 v50, v50, v58
    v_mfma_f32_16x16x32_bf16 v[40:43], a[24:27], v[20:23], v[40:43]
    ds_read_b64_tr_b16 v[196:197], v125 offset:16384
    v_mul_f32 v51, v51, v59
    v_mfma_f32_16x16x32_bf16 v[44:47], a[28:31], v[20:23], v[44:47]
    s_waitcnt lgkmcnt(5)
    ds_read_b64_tr_b16 v[198:199], v125 offset:18432
    v_mul_f32 v52, v52, v60
    v_mfma_f32_16x16x32_bf16 v[32:35], a[32:35], v[24:27], v[32:35]
    ds_read_b128 v[20:23], v105 offset:33024
    v_mul_f32 v53, v53, v61
    v_mfma_f32_16x16x32_bf16 v[36:39], a[36:39], v[24:27], v[36:39]
    buffer_load_dwordx4 v110, s[4:7], s63 offen offset:2048 sc1 lds
    v_mul_f32 v54, v54, v62
    v_mfma_f32_16x16x32_bf16 v[40:43], a[40:43], v[24:27], v[40:43]
    ds_read_b64_tr_b16 v[200:201], v126 offset:16384
    v_mul_f32 v55, v55, v63
    v_mfma_f32_16x16x32_bf16 v[44:47], a[44:47], v[24:27], v[44:47]
    s_waitcnt lgkmcnt(7)
    ds_read_b64_tr_b16 v[202:203], v126 offset:18432
    v_cvt_pk_bf16_f32 v112, v48, v49
    v_mfma_f32_16x16x32_bf16 v[32:35], a[48:51], v[28:31], v[32:35]
    ds_read_b128 v[24:27], v106 offset:33024
    v_cvt_pk_bf16_f32 v113, v50, v51
    v_mfma_f32_16x16x32_bf16 v[36:39], a[52:55], v[28:31], v[36:39]
    buffer_load_dwordx4 v111, s[4:7], s63 offen offset:3072 sc1 lds
    v_cvt_pk_bf16_f32 v114, v52, v53
    v_mfma_f32_16x16x32_bf16 v[40:43], a[56:59], v[28:31], v[40:43]
    s_waitcnt lgkmcnt(15)
    ds_read_b64_tr_b16 v[204:205], v127 offset:16384
    v_cvt_pk_bf16_f32 v115, v54, v55
    v_mfma_f32_16x16x32_bf16 v[44:47], a[60:63], v[28:31], v[44:47]
    s_waitcnt lgkmcnt(7)
    buffer_store_dwordx4 v[112:115], v2, s[4:7], s65 offen sc1
    s_add_u32 s65, s65, 917504
    v_mfma_f32_16x16x32_bf16 v[32:35], a[64:67], v[16:19], v[32:35]
    s_add_u32 m0, s19, 8192
    ds_read_b128 v[28:31], v107 offset:33024
    v_mfma_f32_16x16x32_bf16 v[36:39], a[68:71], v[16:19], v[36:39]
    buffer_load_dwordx4 v116, s[48:51], s18 offen offset:0 lds
    v_mfma_f32_16x16x32_bf16 v[40:43], a[72:75], v[16:19], v[40:43]
    ds_read_b64_tr_b16 v[206:207], v127 offset:18432
    v_mfma_f32_16x16x32_bf16 v[44:47], a[76:79], v[16:19], v[44:47]
    s_waitcnt lgkmcnt(6)
    ds_read_b64_tr_b16 v[208:209], v124 offset:20480
    v_mfma_f32_16x16x32_bf16 v[32:35], a[80:83], v[20:23], v[32:35]
    ds_read_b128 v[16:19], v104 offset:33280
    v_mfma_f32_16x16x32_bf16 v[36:39], a[84:87], v[20:23], v[36:39]
    buffer_load_dwordx4 v117, s[48:51], s18 offen offset:1024 lds
    v_mfma_f32_16x16x32_bf16 v[40:43], a[88:91], v[20:23], v[40:43]
    ds_read_b64_tr_b16 v[210:211], v124 offset:22528
    v_mfma_f32_16x16x32_bf16 v[44:47], a[92:95], v[20:23], v[44:47]
    s_waitcnt lgkmcnt(6)
    ds_read_b64_tr_b16 v[212:213], v125 offset:20480
    v_mfma_f32_16x16x32_bf16 v[32:35], a[96:99], v[24:27], v[32:35]
    s_waitcnt vmcnt(16)
    ds_read_b128 v[20:23], v105 offset:33280
    v_mfma_f32_16x16x32_bf16 v[36:39], a[100:103], v[24:27], v[36:39]
    ds_read_b128 v[64:67], v3 offset:49152
    v_mfma_f32_16x16x32_bf16 v[40:43], a[104:107], v[24:27], v[40:43]
    ds_read_b128 v[68:71], v3 offset:50176
    v_mfma_f32_16x16x32_bf16 v[44:47], a[108:111], v[24:27], v[44:47]
    s_waitcnt lgkmcnt(8)
    ds_read_b128 v[72:75], v3 offset:51200
    v_mfma_f32_16x16x32_bf16 v[32:35], a[112:115], v[28:31], v[32:35]
    ds_read_b128 v[24:27], v106 offset:33280
    v_mfma_f32_16x16x32_bf16 v[36:39], a[116:119], v[28:31], v[36:39]
    ds_read_b128 v[76:79], v3 offset:52224
    v_mfma_f32_16x16x32_bf16 v[40:43], a[120:123], v[28:31], v[40:43]
    buffer_load_dwordx4 v118, s[48:51], s18 offen offset:2048 lds
    v_mfma_f32_16x16x32_bf16 v[44:47], a[124:127], v[28:31], v[44:47]
    s_waitcnt lgkmcnt(8)
    ds_read_b64_tr_b16 v[214:215], v125 offset:22528
    v_mfma_f32_16x16x32_bf16 v[32:35], a[128:131], v[16:19], v[32:35]
    ds_read_b128 v[28:31], v107 offset:33280
    v_mfma_f32_16x16x32_bf16 v[36:39], a[132:135], v[16:19], v[36:39]
    ds_read_b64_tr_b16 v[216:217], v126 offset:20480
    v_mfma_f32_16x16x32_bf16 v[40:43], a[136:139], v[16:19], v[40:43]
    s_waitcnt lgkmcnt(3)
    buffer_load_dwordx4 v119, s[48:51], s18 offen offset:3072 lds
    v_max3_u32 v14, v64, v65, v66
    v_mfma_f32_16x16x32_bf16 v[44:47], a[140:143], v[16:19], v[44:47]
    s_waitcnt lgkmcnt(8)
    ds_read_b64_tr_b16 v[218:219], v126 offset:22528
    v_max3_u32 v14, v14, v67, v68
    v_mfma_f32_16x16x32_bf16 v[32:35], a[144:147], v[20:23], v[32:35]
    s_mov_b32 s8, s40
    ds_read_b128 v[16:19], v104 offset:33536
    v_max3_u32 v14, v14, v69, v70
    v_mfma_f32_16x16x32_bf16 v[36:39], a[148:151], v[20:23], v[36:39]
    s_mov_b32 s9, s41
    ds_read_b64_tr_b16 v[220:221], v127 offset:20480
    v_max3_u32 v14, v14, v71, v72
    v_mfma_f32_16x16x32_bf16 v[40:43], a[152:155], v[20:23], v[40:43]
    s_mov_b32 s10, 0x200000
    ds_read_b64_tr_b16 v[222:223], v127 offset:22528
    v_max3_u32 v14, v14, v73, v74
    v_mfma_f32_16x16x32_bf16 v[44:47], a[156:159], v[20:23], v[44:47]
    s_waitcnt lgkmcnt(8)
    v_max3_u32 v14, v14, v75, v76
    v_max3_u32 v14, v14, v77, v78
    v_mfma_f32_16x16x32_bf16 v[32:35], a[160:163], v[24:27], v[32:35]
    s_mov_b32 s11, 0x20000
    ds_read_b128 v[20:23], v105 offset:33536
    v_max_u32 v14, v14, v79
    v_mfma_f32_16x16x32_bf16 v[36:39], a[164:167], v[24:27], v[36:39]
    s_add_u32 s18, s18, 32768
    v_cmp_eq_u32 vcc, -1, v14
    v_lshrrev_b32 v96, 4, v0
    v_mfma_f32_16x16x32_bf16 v[40:43], a[168:171], v[24:27], v[40:43]
    s_cbranch_vccnz L_slow12
L_back12:
    v_lshlrev_b32 v11, 10, v96
    v_lshl_add_u32 v11, v5, 3, v11
    v_mfma_f32_16x16x32_bf16 v[44:47], a[172:175], v[24:27], v[44:47]
    s_waitcnt lgkmcnt(6)
    v_lshrrev_b32 v97, 2, v5
    v_lshlrev_b32 v97, 3, v97
    v_mfma_f32_16x16x32_bf16 v[32:35], a[176:179], v[28:31], v[32:35]
    s_add_u32 m0, s19, 12288
    ds_read_b128 v[24:27], v106 offset:33536
    v_and_b32 v98, 3, v5
    v_mfma_f32_16x16x32_bf16 v[36:39], a[180:183], v[28:31], v[36:39]
    buffer_load_dwordx4 v116, s[48:51], s18 offen offset:0 lds
    v_add_lshl_u32 v97, v97, v98, 3
    v_mfma_f32_16x16x32_bf16 v[40:43], a[184:187], v[28:31], v[40:43]
    s_lshl_b32 s72, s17, 14
    s_lshl_b32 s73, s16, 7
    s_add_u32 s71, s72, s73
    v_mfma_f32_16x16x32_bf16 v[44:47], a[188:191], v[28:31], v[44:47]
    s_waitcnt lgkmcnt(4)
    s_lshl_b32 s73, s16, 8
    s_add_u32 s66, s73, 16787456
    v_mfma_f32_16x16x32_bf16 v[32:35], a[192:195], v[16:19], v[32:35]
    ds_read_b128 v[28:31], v107 offset:33536
    v_xor_b32 v98, v6, v5
    v_mfma_f32_16x16x32_bf16 v[36:39], a[196:199], v[16:19], v[36:39]
    buffer_load_dwordx4 v117, s[48:51], s18 offen offset:1024 lds
    v_lshlrev_b32 v98, 4, v98
    v_mfma_f32_16x16x32_bf16 v[40:43], a[200:203], v[16:19], v[40:43]
    v_lshl_add_u32 v98, v5, 8, v98
    s_lshl_b32 s72, s3, 12
    v_mfma_f32_16x16x32_bf16 v[44:47], a[204:207], v[16:19], v[44:47]
    s_waitcnt lgkmcnt(2)
    s_add_u32 s72, s72, 131072
    v_add_u32 v92, s72, v98
    s_barrier
    v_mfma_f32_16x16x32_bf16 v[32:35], a[208:211], v[20:23], v[32:35]
    s_waitcnt vmcnt(6)
    ds_read_b128 v[16:19], v104 offset:49152
    v_xor_b32 v93, 64, v92
    v_mfma_f32_16x16x32_bf16 v[36:39], a[212:215], v[20:23], v[36:39]
    s_add_u32 s60, s61, 17170432
    buffer_load_dwordx4 v118, s[48:51], s18 offen offset:2048 lds
    v_lshlrev_b32 v7, 26, v6
    v_mfma_f32_16x16x32_bf16 v[40:43], a[216:219], v[20:23], v[40:43]
    v_lshl_add_u32 v7, v5, 2, v7
    v_mov_b32 v8, s56
    v_mfma_f32_16x16x32_bf16 v[44:47], a[220:223], v[20:23], v[44:47]
    s_waitcnt lgkmcnt(2)
    buffer_store_dword v8, v7, s[4:7], s60 offen sc1
    v_xor_b32 v94, 128, v92
    v_mfma_f32_16x16x32_bf16 v[32:35], a[224:227], v[24:27], v[32:35]
    ds_read_b128 v[20:23], v105 offset:49152
    v_xor_b32 v95, 192, v92
    v_mfma_f32_16x16x32_bf16 v[36:39], a[228:231], v[24:27], v[36:39]
    buffer_load_dwordx4 v119, s[48:51], s18 offen offset:3072 lds
    v_xor_b32 v10, v5, v96
    v_mfma_f32_16x16x32_bf16 v[40:43], a[232:235], v[24:27], v[40:43]
    s_add_u32 s18, s18, 32768
    v_lshlrev_b32 v10, 4, v10
    v_lshl_add_u32 v10, v96, 8, v10
    v_mfma_f32_16x16x32_bf16 v[44:47], a[236:239], v[24:27], v[44:47]
    s_waitcnt lgkmcnt(2)
    v_add_u32 v10, 131072, v10
    v_bfe_u32 v98, v1, 2, 1
    v_mfma_f32_16x16x32_bf16 v[32:35], a[240:243], v[28:31], v[32:35]
    ds_read_b128 v[24:27], v106 offset:49152
    v_lshlrev_b32 v98, 7, v98
    v_mfma_f32_16x16x32_bf16 v[36:39], a[244:247], v[28:31], v[36:39]
    v_and_b32 v99, 3, v1
    v_add_lshl_u32 v98, v98, v99, 7
    v_mfma_f32_16x16x32_bf16 v[40:43], a[248:251], v[28:31], v[40:43]
    s_lshl_b32 s72, s17, 9
    s_add_u32 s72, s72, 17104896
    v_mfma_f32_16x16x32_bf16 v[44:47], a[252:255], v[28:31], v[44:47]
    s_waitcnt lgkmcnt(2)
    buffer_load_dword v99, v98, s[4:7], s72 offen sc1
    buffer_load_dwordx2 v[90:91], v97, s[4:7], s66 offen sc1
    v_mfma_f32_16x16x32_bf16 v[48:51], a[0:3], v[16:19], 0
    s_add_u32 m0, s69, 16384
    ds_read_b128 v[28:31], v107 offset:49152
    s_add_u32 s63, s70, 1835008
    v_mfma_f32_16x16x32_bf16 v[52:55], a[4:7], v[16:19], 0
    s_waitcnt vmcnt(16)
    buffer_load_dwordx4 v108, s[4:7], s63 offen offset:0 sc1 lds
    v_mfma_f32_16x16x32_bf16 v[56:59], a[8:11], v[16:19], 0
    ds_read_b64_tr_b16 v[224:225], v124 offset:0
    v_mfma_f32_16x16x32_bf16 v[60:63], a[12:15], v[16:19], 0
    s_waitcnt lgkmcnt(3)
    ds_read_b64_tr_b16 v[226:227], v124 offset:2048
    v_mul_f32 v32, v32, v40
    v_mfma_f32_16x16x32_bf16 v[48:51], a[16:19], v[20:23], v[48:51]
    ds_read_b128 v[16:19], v104 offset:49408
    v_mul_f32 v33, v33, v41
    v_mfma_f32_16x16x32_bf16 v[52:55], a[20:23], v[20:23], v[52:55]
    buffer_load_dwordx4 v109, s[4:7], s63 offen offset:1024 sc1 lds
    v_mul_f32 v34, v34, v42
    v_mfma_f32_16x16x32_bf16 v[56:59], a[24:27], v[20:23], v[56:59]
    ds_read_b64_tr_b16 v[228:229], v125 offset:0
    v_mul_f32 v35, v35, v43
    v_mfma_f32_16x16x32_bf16 v[60:63], a[28:31], v[20:23], v[60:63]
    s_waitcnt lgkmcnt(5)
    ds_read_b64_tr_b16 v[230:231], v125 offset:2048
    v_mul_f32 v36, v36, v44
    v_mfma_f32_16x16x32_bf16 v[48:51], a[32:35], v[24:27], v[48:51]
    ds_read_b128 v[20:23], v105 offset:49408
    v_mul_f32 v37, v37, v45
    v_mfma_f32_16x16x32_bf16 v[52:55], a[36:39], v[24:27], v[52:55]
    buffer_load_dwordx4 v110, s[4:7], s63 offen offset:2048 sc1 lds
    v_mul_f32 v38, v38, v46
    v_mfma_f32_16x16x32_bf16 v[56:59], a[40:43], v[24:27], v[56:59]
    ds_read_b64_tr_b16 v[232:233], v126 offset:0
    v_mul_f32 v39, v39, v47
    v_mfma_f32_16x16x32_bf16 v[60:63], a[44:47], v[24:27], v[60:63]
    s_waitcnt lgkmcnt(7)
    ds_read_b64_tr_b16 v[234:235], v126 offset:2048
    v_cvt_pk_bf16_f32 v112, v32, v33
    v_mfma_f32_16x16x32_bf16 v[48:51], a[48:51], v[28:31], v[48:51]
    ds_read_b128 v[24:27], v106 offset:49408
    v_cvt_pk_bf16_f32 v113, v34, v35
    v_mfma_f32_16x16x32_bf16 v[52:55], a[52:55], v[28:31], v[52:55]
    buffer_load_dwordx4 v111, s[4:7], s63 offen offset:3072 sc1 lds
    v_cvt_pk_bf16_f32 v114, v36, v37
    v_mfma_f32_16x16x32_bf16 v[56:59], a[56:59], v[28:31], v[56:59]
    s_waitcnt lgkmcnt(15)
    ds_read_b64_tr_b16 v[236:237], v127 offset:0
    v_cvt_pk_bf16_f32 v115, v38, v39
    v_mfma_f32_16x16x32_bf16 v[60:63], a[60:63], v[28:31], v[60:63]
    s_waitcnt lgkmcnt(7)
    buffer_store_dwordx4 v[112:115], v2, s[4:7], s65 offen sc1
    s_add_u32 s65, s65, 917504
    v_mfma_f32_16x16x32_bf16 v[48:51], a[64:67], v[16:19], v[48:51]
    s_add_u32 m0, s19, 16384
    ds_read_b128 v[28:31], v107 offset:49408
    v_mfma_f32_16x16x32_bf16 v[52:55], a[68:71], v[16:19], v[52:55]
    buffer_load_dwordx4 v116, s[48:51], s18 offen offset:0 lds
    v_mfma_f32_16x16x32_bf16 v[56:59], a[72:75], v[16:19], v[56:59]
    ds_read_b64_tr_b16 v[238:239], v127 offset:2048
    v_mfma_f32_16x16x32_bf16 v[60:63], a[76:79], v[16:19], v[60:63]
    s_waitcnt lgkmcnt(6)
    ds_read_b64_tr_b16 v[240:241], v124 offset:4096
    v_mfma_f32_16x16x32_bf16 v[48:51], a[80:83], v[20:23], v[48:51]
    ds_read_b128 v[16:19], v104 offset:49664
    v_mfma_f32_16x16x32_bf16 v[52:55], a[84:87], v[20:23], v[52:55]
    buffer_load_dwordx4 v117, s[48:51], s18 offen offset:1024 lds
    v_mfma_f32_16x16x32_bf16 v[56:59], a[88:91], v[20:23], v[56:59]
    ds_read_b64_tr_b16 v[242:243], v124 offset:6144
    v_mfma_f32_16x16x32_bf16 v[60:63], a[92:95], v[20:23], v[60:63]
    s_waitcnt lgkmcnt(6)
    ds_read_b64_tr_b16 v[244:245], v125 offset:4096
    v_mfma_f32_16x16x32_bf16 v[48:51], a[96:99], v[24:27], v[48:51]
    s_waitcnt vmcnt(19)
    ds_read_b128 v[20:23], v105 offset:49664
    v_mfma_f32_16x16x32_bf16 v[52:55], a[100:103], v[24:27], v[52:55]
    ds_read_b128 v[64:67], v3 offset:0
    v_mfma_f32_16x16x32_bf16 v[56:59], a[104:107], v[24:27], v[56:59]
    ds_read_b128 v[68:71], v3 offset:1024
    v_mfma_f32_16x16x32_bf16 v[60:63], a[108:111], v[24:27], v[60:63]
    s_waitcnt lgkmcnt(8)
    ds_read_b128 v[72:75], v3 offset:2048
    v_mfma_f32_16x16x32_bf16 v[48:51], a[112:115], v[28:31], v[48:51]
    ds_read_b128 v[24:27], v106 offset:49664
    v_mfma_f32_16x16x32_bf16 v[52:55], a[116:119], v[28:31], v[52:55]
    ds_read_b128 v[76:79], v3 offset:3072
    v_mfma_f32_16x16x32_bf16 v[56:59], a[120:123], v[28:31], v[56:59]
    buffer_load_dwordx4 v118, s[48:51], s18 offen offset:2048 lds
    v_mfma_f32_16x16x32_bf16 v[60:63], a[124:127], v[28:31], v[60:63]
    s_waitcnt lgkmcnt(8)
    ds_read_b64_tr_b16 v[246:247], v125 offset:6144
    v_mfma_f32_16x16x32_bf16 v[48:51], a[128:131], v[16:19], v[48:51]
    ds_read_b128 v[28:31], v107 offset:49664
    v_mfma_f32_16x16x32_bf16 v[52:55], a[132:135], v[16:19], v[52:55]
    ds_read_b64_tr_b16 v[248:249], v126 offset:4096
    v_mfma_f32_16x16x32_bf16 v[56:59], a[136:139], v[16:19], v[56:59]
    s_waitcnt lgkmcnt(3)
    buffer_load_dwordx4 v119, s[48:51], s18 offen offset:3072 lds
    v_max3_u32 v14, v64, v65, v66
    v_mfma_f32_16x16x32_bf16 v[60:63], a[140:143], v[16:19], v[60:63]
    s_waitcnt lgkmcnt(8)
    ds_read_b64_tr_b16 v[250:251], v126 offset:6144
    v_max3_u32 v14, v14, v67, v68
    v_mfma_f32_16x16x32_bf16 v[48:51], a[144:147], v[20:23], v[48:51]
    s_add_u32 s18, s18, 32768
    ds_read_b128 v[16:19], v104 offset:49920
    v_max3_u32 v14, v14, v69, v70
    v_mfma_f32_16x16x32_bf16 v[52:55], a[148:151], v[20:23], v[52:55]
    s_add_u32 m0, s19, 20480
    ds_read_b64_tr_b16 v[252:253], v127 offset:4096
    v_max3_u32 v14, v14, v71, v72
    v_mfma_f32_16x16x32_bf16 v[56:59], a[152:155], v[20:23], v[56:59]
    buffer_load_dwordx4 v116, s[48:51], s18 offen offset:0 lds
    v_max3_u32 v14, v14, v73, v74
    v_mfma_f32_16x16x32_bf16 v[60:63], a[156:159], v[20:23], v[60:63]
    s_waitcnt lgkmcnt(7)
    ds_read_b64_tr_b16 v[254:255], v127 offset:6144
    v_max3_u32 v14, v14, v75, v76
    v_mfma_f32_16x16x32_bf16 v[48:51], a[160:163], v[24:27], v[48:51]
    ds_read_b128 v[20:23], v105 offset:49920
    v_max3_u32 v14, v14, v77, v78
    v_mfma_f32_16x16x32_bf16 v[52:55], a[164:167], v[24:27], v[52:55]
    v_max_u32 v14, v14, v79
    v_cmp_eq_u32 vcc, -1, v14
    v_mfma_f32_16x16x32_bf16 v[56:59], a[168:171], v[24:27], v[56:59]
    s_cbranch_vccnz L_slow13
L_back13:
    buffer_load_dwordx4 v117, s[48:51], s18 offen offset:1024 lds
    v_min_u32 v13, 13, v1
    v_mfma_f32_16x16x32_bf16 v[60:63], a[172:175], v[24:27], v[60:63]
    s_waitcnt lgkmcnt(6)
    v_lshlrev_b32 v13, 7, v13
    s_add_u32 s62, s25, 17563648
    v_mfma_f32_16x16x32_bf16 v[48:51], a[176:179], v[28:31], v[48:51]
    ds_read_b128 v[24:27], v106 offset:49920
    v_mfma_f32_16x16x32_bf16 v[52:55], a[180:183], v[28:31], v[52:55]
    buffer_load_dword v12, v13, s[4:7], s62 offen sc1
    v_mfma_f32_16x16x32_bf16 v[56:59], a[184:187], v[28:31], v[56:59]
    buffer_load_dwordx4 v118, s[48:51], s18 offen offset:2048 lds
    v_mfma_f32_16x16x32_bf16 v[60:63], a[188:191], v[28:31], v[60:63]
    s_waitcnt lgkmcnt(4)
    v_mfma_f32_16x16x32_bf16 v[48:51], a[192:195], v[16:19], v[48:51]
    ds_read_b128 v[28:31], v107 offset:49920
    v_mfma_f32_16x16x32_bf16 v[52:55], a[196:199], v[16:19], v[52:55]
    v_mfma_f32_16x16x32_bf16 v[56:59], a[200:203], v[16:19], v[56:59]
    buffer_load_dwordx4 v119, s[48:51], s18 offen offset:3072 lds
    s_add_u32 s18, s18, 32768
    v_mfma_f32_16x16x32_bf16 v[60:63], a[204:207], v[16:19], v[60:63]
    s_waitcnt lgkmcnt(2)
    s_barrier
    v_mfma_f32_16x16x32_bf16 v[48:51], a[208:211], v[20:23], v[48:51]
    ds_read_b128 v[16:19], v104 offset:0
    v_mfma_f32_16x16x32_bf16 v[52:55], a[212:215], v[20:23], v[52:55]
    v_mfma_f32_16x16x32_bf16 v[56:59], a[216:219], v[20:23], v[56:59]
    v_mfma_f32_16x16x32_bf16 v[60:63], a[220:223], v[20:23], v[60:63]
    s_waitcnt lgkmcnt(2)
    v_mfma_f32_16x16x32_bf16 v[48:51], a[224:227], v[24:27], v[48:51]
    ds_read_b128 v[20:23], v105 offset:0
    v_mfma_f32_16x16x32_bf16 v[52:55], a[228:231], v[24:27], v[52:55]
    v_mfma_f32_16x16x32_bf16 v[56:59], a[232:235], v[24:27], v[56:59]
    v_mfma_f32_16x16x32_bf16 v[60:63], a[236:239], v[24:27], v[60:63]
    s_waitcnt lgkmcnt(2)
    v_mfma_f32_16x16x32_bf16 v[48:51], a[240:243], v[28:31], v[48:51]
    ds_read_b128 v[24:27], v106 offset:0
    v_mfma_f32_16x16x32_bf16 v[52:55], a[244:247], v[28:31], v[52:55]
    v_mfma_f32_16x16x32_bf16 v[56:59], a[248:251], v[28:31], v[56:59]
    v_mfma_f32_16x16x32_bf16 v[60:63], a[252:255], v[28:31], v[60:63]
    s_waitcnt lgkmcnt(2)
    v_mfma_f32_16x16x32_bf16 v[32:35], a[0:3], v[16:19], 0
    s_waitcnt lgkmcnt(6)
    ds_read_b128 v[28:31], v107 offset:0
    s_add_u32 m0, s19, 0
    v_mfma_f32_16x16x32_bf16 v[36:39], a[4:7], v[16:19], 0
    buffer_load_dwordx4 v116, s[48:51], s18 offen offset:0 lds
    v_mfma_f32_16x16x32_bf16 v[40:43], a[8:11], v[16:19], 0
    v_mfma_f32_16x16x32_bf16 v[44:47], a[12:15], v[16:19], 0
    s_waitcnt lgkmcnt(2)
    v_mul_f32 v48, v48, v56
    v_mul_f32 v49, v49, v57
    v_mfma_f32_16x16x32_bf16 v[32:35], a[16:19], v[20:23], v[32:35]
    ds_read_b128 v[16:19], v104 offset:256
    v_mul_f32 v50, v50, v58
    v_mfma_f32_16x16x32_bf16 v[36:39], a[20:23], v[20:23], v[36:39]
    buffer_load_dwordx4 v117, s[48:51], s18 offen offset:1024 lds
    v_mul_f32 v51, v51, v59
    v_mfma_f32_16x16x32_bf16 v[40:43], a[24:27], v[20:23], v[40:43]
    v_mul_f32 v52, v52, v60
    v_mul_f32 v53, v53, v61
    v_mfma_f32_16x16x32_bf16 v[44:47], a[28:31], v[20:23], v[44:47]
    s_waitcnt lgkmcnt(2)
    v_mul_f32 v54, v54, v62
    v_mul_f32 v55, v55, v63
    v_mfma_f32_16x16x32_bf16 v[32:35], a[32:35], v[24:27], v[32:35]
    ds_read_b128 v[20:23], v105 offset:256
    v_cvt_pk_bf16_f32 v112, v48, v49
    v_mfma_f32_16x16x32_bf16 v[36:39], a[36:39], v[24:27], v[36:39]
    buffer_load_dwordx4 v118, s[48:51], s18 offen offset:2048 lds
    v_cvt_pk_bf16_f32 v113, v50, v51
    v_mfma_f32_16x16x32_bf16 v[40:43], a[40:43], v[24:27], v[40:43]
    v_cvt_pk_bf16_f32 v114, v52, v53
    v_cvt_pk_bf16_f32 v115, v54, v55
    v_mfma_f32_16x16x32_bf16 v[44:47], a[44:47], v[24:27], v[44:47]
    s_waitcnt lgkmcnt(2)
    buffer_store_dwordx4 v[112:115], v2, s[4:7], s65 offen sc1
    s_add_u32 s65, s65, 917504
    v_mfma_f32_16x16x32_bf16 v[32:35], a[48:51], v[28:31], v[32:35]
    s_waitcnt vmcnt(18)
    ds_read_b128 v[24:27], v106 offset:256
    v_cmp_ne_u32 vcc, s56, v99
    v_mfma_f32_16x16x32_bf16 v[36:39], a[52:55], v[28:31], v[36:39]
    s_cbranch_vccnz L_slow14
L_back14:
    buffer_load_dwordx4 v119, s[48:51], s18 offen offset:3072 lds
    s_add_u32 s62, s71, 6291456
    v_mfma_f32_16x16x32_bf16 v[40:43], a[56:59], v[28:31], v[40:43]
    s_add_u32 s18, s18, 32768
    buffer_load_dwordx2 v[80:81], v11, s[4:7], s62 offen sc1
    s_add_u32 s62, s71, 6815744
    v_mfma_f32_16x16x32_bf16 v[44:47], a[60:63], v[28:31], v[44:47]
    s_waitcnt lgkmcnt(2)
    buffer_load_dwordx2 v[82:83], v11, s[4:7], s62 offen sc1
    s_add_u32 s62, s71, 7340032
    v_mfma_f32_16x16x32_bf16 v[32:35], a[64:67], v[16:19], v[32:35]
    s_add_u32 m0, s19, 4096
    ds_read_b128 v[28:31], v107 offset:256
    v_mfma_f32_16x16x32_bf16 v[36:39], a[68:71], v[16:19], v[36:39]
    buffer_load_dwordx2 v[84:85], v11, s[4:7], s62 offen sc1
    s_add_u32 s62, s71, 7864320
    v_mfma_f32_16x16x32_bf16 v[40:43], a[72:75], v[16:19], v[40:43]
    buffer_load_dwordx2 v[86:87], v11, s[4:7], s62 offen sc1
    v_max_u32 v14, v90, v91
    v_mfma_f32_16x16x32_bf16 v[44:47], a[76:79], v[16:19], v[44:47]
    s_waitcnt lgkmcnt(2)
    buffer_load_dwordx4 v116, s[48:51], s18 offen offset:0 lds
    v_cmp_eq_u32 vcc, -1, v14
    v_mfma_f32_16x16x32_bf16 v[32:35], a[80:83], v[20:23], v[32:35]
    s_cbranch_vccnz L_slow15
L_back15:
    ds_read_b128 v[16:19], v104 offset:512
    v_lshlrev_b32 v88, 16, v90
    v_mfma_f32_16x16x32_bf16 v[36:39], a[84:87], v[20:23], v[36:39]
    v_and_b32 v89, s57, v90
    v_lshlrev_b32 v90, 16, v91
    v_mfma_f32_16x16x32_bf16 v[40:43], a[88:91], v[20:23], v[40:43]
    v_and_b32 v91, s57, v91
    v_mfma_f32_16x16x32_bf16 v[44:47], a[92:95], v[20:23], v[44:47]
    s_waitcnt lgkmcnt(2)
    buffer_load_dwordx4 v117, s[48:51], s18 offen offset:1024 lds
    v_mfma_f32_16x16x32_bf16 v[32:35], a[96:99], v[24:27], v[32:35]
    s_waitcnt vmcnt(21)
    ds_read_b128 v[20:23], v105 offset:512
    v_mfma_f32_16x16x32_bf16 v[36:39], a[100:103], v[24:27], v[36:39]
    ds_read_b128 v[64:67], v3 offset:16384
    v_mfma_f32_16x16x32_bf16 v[40:43], a[104:107], v[24:27], v[40:43]
    ds_read_b128 v[68:71], v3 offset:17408
    v_mfma_f32_16x16x32_bf16 v[44:47], a[108:111], v[24:27], v[44:47]
    s_waitcnt lgkmcnt(4)
    ds_read_b128 v[72:75], v3 offset:18432
    v_mfma_f32_16x16x32_bf16 v[32:35], a[112:115], v[28:31], v[32:35]
    ds_read_b128 v[24:27], v106 offset:512
    v_mfma_f32_16x16x32_bf16 v[36:39], a[116:119], v[28:31], v[36:39]
    ds_read_b128 v[76:79], v3 offset:19456
    v_mfma_f32_16x16x32_bf16 v[40:43], a[120:123], v[28:31], v[40:43]
    buffer_load_dwordx4 v118, s[48:51], s18 offen offset:2048 lds
    v_mfma_f32_16x16x32_bf16 v[44:47], a[124:127], v[28:31], v[44:47]
    s_waitcnt lgkmcnt(6)
    v_mfma_f32_16x16x32_bf16 v[32:35], a[128:131], v[16:19], v[32:35]
    ds_read_b128 v[28:31], v107 offset:512
    v_mfma_f32_16x16x32_bf16 v[36:39], a[132:135], v[16:19], v[36:39]
    v_mfma_f32_16x16x32_bf16 v[40:43], a[136:139], v[16:19], v[40:43]
    s_waitcnt lgkmcnt(1)
    buffer_load_dwordx4 v119, s[48:51], s18 offen offset:3072 lds
    v_max3_u32 v14, v64, v65, v66
    v_mfma_f32_16x16x32_bf16 v[44:47], a[140:143], v[16:19], v[44:47]
    s_waitcnt lgkmcnt(6)
    v_max3_u32 v14, v14, v67, v68
    v_max3_u32 v14, v14, v69, v70
    v_mfma_f32_16x16x32_bf16 v[32:35], a[144:147], v[20:23], v[32:35]
    s_add_u32 s18, s18, 32768
    ds_read_b128 v[16:19], v104 offset:768
    v_max3_u32 v14, v14, v71, v72
    v_mfma_f32_16x16x32_bf16 v[36:39], a[148:151], v[20:23], v[36:39]
    v_max3_u32 v14, v14, v73, v74
    v_max3_u32 v14, v14, v75, v76
    v_mfma_f32_16x16x32_bf16 v[40:43], a[152:155], v[20:23], v[40:43]
    v_max3_u32 v14, v14, v77, v78
    v_max_u32 v14, v14, v79
    v_mfma_f32_16x16x32_bf16 v[44:47], a[156:159], v[20:23], v[44:47]
    s_waitcnt lgkmcnt(3)
    v_cmp_eq_u32 vcc, -1, v14
    s_nop 0
    s_cbranch_vccnz L_slow16
L_back16:
    v_mfma_f32_16x16x32_bf16 v[32:35], a[160:163], v[24:27], v[32:35]
    s_waitcnt vmcnt(15)
    ds_read_b128 v[20:23], v105 offset:768
    v_cmp_ne_u32 vcc, s56, v12
    v_mfma_f32_16x16x32_bf16 v[36:39], a[164:167], v[24:27], v[36:39]
    s_cbranch_vccnz L_slow17
L_back17:
    v_min_u32 v9, 13, v1
    v_lshlrev_b32 v9, 7, v9
    v_mfma_f32_16x16x32_bf16 v[40:43], a[168:171], v[24:27], v[40:43]
    s_add_u32 s62, s25, 17170432
    buffer_load_dword v15, v9, s[4:7], s62 offen sc1
    v_mfma_f32_16x16x32_bf16 v[44:47], a[172:175], v[24:27], v[44:47]
    s_waitcnt lgkmcnt(2)
    v_mfma_f32_16x16x32_bf16 v[32:35], a[176:179], v[28:31], v[32:35]
    ds_read_b128 v[24:27], v106 offset:768
    v_mfma_f32_16x16x32_bf16 v[36:39], a[180:183], v[28:31], v[36:39]
    v_mfma_f32_16x16x32_bf16 v[40:43], a[184:187], v[28:31], v[40:43]
    v_mfma_f32_16x16x32_bf16 v[44:47], a[188:191], v[28:31], v[44:47]
    s_waitcnt lgkmcnt(2)
    v_mfma_f32_16x16x32_bf16 v[32:35], a[192:195], v[16:19], v[32:35]
    ds_read_b128 v[28:31], v107 offset:768
    v_mfma_f32_16x16x32_bf16 v[36:39], a[196:199], v[16:19], v[36:39]
    v_mfma_f32_16x16x32_bf16 v[40:43], a[200:203], v[16:19], v[40:43]
    v_mfma_f32_16x16x32_bf16 v[44:47], a[204:207], v[16:19], v[44:47]
    s_waitcnt lgkmcnt(2)
    s_barrier
    v_mfma_f32_16x16x32_bf16 v[32:35], a[208:211], v[20:23], v[32:35]
    s_waitcnt vmcnt(10)
    ds_read_b128 v[16:19], v104 offset:16384
    s_add_u32 s60, s61, 17301504
    v_mfma_f32_16x16x32_bf16 v[36:39], a[212:215], v[20:23], v[36:39]
    v_lshlrev_b32 v7, 26, v6
    v_lshl_add_u32 v7, v5, 2, v7
    v_mfma_f32_16x16x32_bf16 v[40:43], a[216:219], v[20:23], v[40:43]
    v_mov_b32 v8, s56
    v_mfma_f32_16x16x32_bf16 v[44:47], a[220:223], v[20:23], v[44:47]
    s_waitcnt lgkmcnt(2)
    buffer_store_dword v8, v7, s[4:7], s60 offen sc1
    v_mfma_f32_16x16x32_bf16 v[32:35], a[224:227], v[24:27], v[32:35]
    ds_read_b128 v[20:23], v105 offset:16384
    v_mfma_f32_16x16x32_bf16 v[36:39], a[228:231], v[24:27], v[36:39]
    v_mfma_f32_16x16x32_bf16 v[40:43], a[232:235], v[24:27], v[40:43]
    v_mfma_f32_16x16x32_bf16 v[44:47], a[236:239], v[24:27], v[44:47]
    s_waitcnt lgkmcnt(2)
    v_mfma_f32_16x16x32_bf16 v[32:35], a[240:243], v[28:31], v[32:35]
    ds_read_b128 v[24:27], v106 offset:16384
    v_mfma_f32_16x16x32_bf16 v[36:39], a[244:247], v[28:31], v[36:39]
    v_mfma_f32_16x16x32_bf16 v[40:43], a[248:251], v[28:31], v[40:43]
    v_mfma_f32_16x16x32_bf16 v[44:47], a[252:255], v[28:31], v[44:47]
    s_waitcnt lgkmcnt(2)
    v_mfma_f32_16x16x32_bf16 v[48:51], a[0:3], v[16:19], 0
    ds_read_b128 v[28:31], v107 offset:16384
    v_mfma_f32_16x16x32_bf16 v[52:55], a[4:7], v[16:19], 0
    v_mfma_f32_16x16x32_bf16 v[56:59], a[8:11], v[16:19], 0
    v_mfma_f32_16x16x32_bf16 v[60:63], a[12:15], v[16:19], 0
    s_waitcnt lgkmcnt(2)
    v_mul_f32 v32, v32, v40
    v_mul_f32 v33, v33, v41
    v_mfma_f32_16x16x32_bf16 v[48:51], a[16:19], v[20:23], v[48:51]
    s_add_u32 s63, s24, 0
    ds_read_b128 v[16:19], v104 offset:16640
    v_mul_f32 v34, v34, v42
    v_mfma_f32_16x16x32_bf16 v[52:55], a[20:23], v[20:23], v[52:55]
    buffer_load_dwordx4 a[0:3], v2, s[4:7], s63 offen offset:0 sc1
    v_mul_f32 v35, v35, v43
    v_mfma_f32_16x16x32_bf16 v[56:59], a[24:27], v[20:23], v[56:59]
    v_mul_f32 v36, v36, v44
    v_mul_f32 v37, v37, v45
    v_mfma_f32_16x16x32_bf16 v[60:63], a[28:31], v[20:23], v[60:63]
    s_waitcnt lgkmcnt(2)
    v_mul_f32 v38, v38, v46
    v_mul_f32 v39, v39, v47
    v_mfma_f32_16x16x32_bf16 v[48:51], a[32:35], v[24:27], v[48:51]
    ds_read_b128 v[20:23], v105 offset:16640
    v_cvt_pk_bf16_f32 v112, v32, v33
    v_mfma_f32_16x16x32_bf16 v[52:55], a[36:39], v[24:27], v[52:55]
    buffer_load_dwordx4 a[4:7], v2, s[4:7], s63 offen offset:1024 sc1
    v_cvt_pk_bf16_f32 v113, v34, v35
    v_mfma_f32_16x16x32_bf16 v[56:59], a[40:43], v[24:27], v[56:59]
    v_cvt_pk_bf16_f32 v114, v36, v37
    v_cvt_pk_bf16_f32 v115, v38, v39
    v_mfma_f32_16x16x32_bf16 v[60:63], a[44:47], v[24:27], v[60:63]
    s_waitcnt lgkmcnt(2)
    v_min_u32 v112, s58, v112
    v_min_u32 v113, s58, v113
    v_mfma_f32_16x16x32_bf16 v[48:51], a[48:51], v[28:31], v[48:51]
    ds_read_b128 v[24:27], v106 offset:16640
    v_min_u32 v114, s58, v114
    v_mfma_f32_16x16x32_bf16 v[52:55], a[52:55], v[28:31], v[52:55]
    buffer_load_dwordx4 a[8:11], v2, s[4:7], s63 offen offset:2048 sc1
    v_min_u32 v115, s58, v115
    v_mfma_f32_16x16x32_bf16 v[56:59], a[56:59], v[28:31], v[56:59]
    buffer_store_dwordx4 v[112:115], v2, s[4:7], s65 offen sc1
    s_add_u32 s65, s65, 917504
    v_mfma_f32_16x16x32_bf16 v[60:63], a[60:63], v[28:31], v[60:63]
    s_waitcnt lgkmcnt(2)
    v_mfma_f32_16x16x32_bf16 v[48:51], a[64:67], v[16:19], v[48:51]
    ds_read_b128 v[28:31], v107 offset:16640
    v_mfma_f32_16x16x32_bf16 v[52:55], a[68:71], v[16:19], v[52:55]
    buffer_load_dwordx4 a[12:15], v2, s[4:7], s63 offen offset:3072 sc1
    s_add_u32 s63, s24, 4096
    v_mfma_f32_16x16x32_bf16 v[56:59], a[72:75], v[16:19], v[56:59]
    v_mfma_f32_16x16x32_bf16 v[60:63], a[76:79], v[16:19], v[60:63]
    s_waitcnt lgkmcnt(2)
    v_mfma_f32_16x16x32_bf16 v[48:51], a[80:83], v[20:23], v[48:51]
    s_waitcnt vmcnt(6)
    ds_read_b128 v[16:19], v104 offset:16896
    v_cmp_ne_u32 vcc, s56, v15
    v_mfma_f32_16x16x32_bf16 v[52:55], a[84:87], v[20:23], v[52:55]
    s_cbranch_vccnz L_slow18
L_back18:
    buffer_load_dwordx4 a[16:19], v2, s[4:7], s63 offen offset:0 sc1
    v_mfma_f32_16x16x32_bf16 v[56:59], a[88:91], v[20:23], v[56:59]
    v_mfma_f32_16x16x32_bf16 v[60:63], a[92:95], v[20:23], v[60:63]
    s_waitcnt lgkmcnt(2)
    v_mfma_f32_16x16x32_bf16 v[48:51], a[96:99], v[24:27], v[48:51]
    ds_read_b128 v[20:23], v105 offset:16896
    v_mfma_f32_16x16x32_bf16 v[52:55], a[100:103], v[24:27], v[52:55]
    buffer_load_dwordx4 a[20:23], v2, s[4:7], s63 offen offset:1024 sc1
    v_mfma_f32_16x16x32_bf16 v[56:59], a[104:107], v[24:27], v[56:59]
    v_mfma_f32_16x16x32_bf16 v[60:63], a[108:111], v[24:27], v[60:63]
    s_waitcnt lgkmcnt(2)
    v_mfma_f32_16x16x32_bf16 v[48:51], a[112:115], v[28:31], v[48:51]
    ds_read_b128 v[24:27], v106 offset:16896
    v_mfma_f32_16x16x32_bf16 v[52:55], a[116:119], v[28:31], v[52:55]
    buffer_load_dwordx4 a[24:27], v2, s[4:7], s63 offen offset:2048 sc1
    v_mfma_f32_16x16x32_bf16 v[56:59], a[120:123], v[28:31], v[56:59]
    v_mfma_f32_16x16x32_bf16 v[60:63], a[124:127], v[28:31], v[60:63]
    s_waitcnt lgkmcnt(2)
    v_mfma_f32_16x16x32_bf16 v[48:51], a[128:131], v[16:19], v[48:51]
    s_waitcnt vmcnt(10)
    ds_read_b128 v[28:31], v107 offset:16896
    v_mfma_f32_16x16x32_bf16 v[52:55], a[132:135], v[16:19], v[52:55]
    buffer_load_dwordx4 a[28:31], v2, s[4:7], s63 offen offset:3072 sc1
    s_add_u32 s63, s24, 8192
    v_mfma_f32_16x16x32_bf16 v[56:59], a[136:139], v[16:19], v[56:59]
    ds_read_b64_tr_b16 a[112:113], v124 offset:8192
    v_mfma_f32_16x16x32_bf16 v[60:63], a[140:143], v[16:19], v[60:63]
    s_waitcnt lgkmcnt(3)
    ds_read_b64_tr_b16 a[114:115], v124 offset:10240
    v_mfma_f32_16x16x32_bf16 v[48:51], a[144:147], v[20:23], v[48:51]
    ds_read_b128 v[16:19], v104 offset:17152
    v_mfma_f32_16x16x32_bf16 v[52:55], a[148:151], v[20:23], v[52:55]
    buffer_load_dwordx4 a[32:35], v2, s[4:7], s63 offen offset:0 sc1
    v_mfma_f32_16x16x32_bf16 v[56:59], a[152:155], v[20:23], v[56:59]
    ds_read_b64_tr_b16 a[116:117], v125 offset:8192
    v_mfma_f32_16x16x32_bf16 v[60:63], a[156:159], v[20:23], v[60:63]
    s_waitcnt lgkmcnt(5)
    ds_read_b64_tr_b16 a[118:119], v125 offset:10240
    v_mfma_f32_16x16x32_bf16 v[48:51], a[160:163], v[24:27], v[48:51]
    ds_read_b128 v[20:23], v105 offset:17152
    v_mfma_f32_16x16x32_bf16 v[52:55], a[164:167], v[24:27], v[52:55]
    buffer_load_dwordx4 a[36:39], v2, s[4:7], s63 offen offset:1024 sc1
    v_mfma_f32_16x16x32_bf16 v[56:59], a[168:171], v[24:27], v[56:59]
    ds_read_b64_tr_b16 a[120:121], v126 offset:8192
    v_mfma_f32_16x16x32_bf16 v[60:63], a[172:175], v[24:27], v[60:63]
    s_waitcnt lgkmcnt(7)
    ds_read_b64_tr_b16 a[122:123], v126 offset:10240
    v_mfma_f32_16x16x32_bf16 v[48:51], a[176:179], v[28:31], v[48:51]
    ds_read_b128 v[24:27], v106 offset:17152
    v_mfma_f32_16x16x32_bf16 v[52:55], a[180:183], v[28:31], v[52:55]
    buffer_load_dwordx4 a[40:43], v2, s[4:7], s63 offen offset:2048 sc1
    v_mfma_f32_16x16x32_bf16 v[56:59], a[184:187], v[28:31], v[56:59]
    ds_read_b64_tr_b16 a[124:125], v127 offset:8192
    v_mfma_f32_16x16x32_bf16 v[60:63], a[188:191], v[28:31], v[60:63]
    s_waitcnt lgkmcnt(7)
    ds_read_b64_tr_b16 a[126:127], v127 offset:10240
    v_mfma_f32_16x16x32_bf16 v[48:51], a[192:195], v[16:19], v[48:51]
    ds_read_b128 v[28:31], v107 offset:17152
    v_mfma_f32_16x16x32_bf16 v[52:55], a[196:199], v[16:19], v[52:55]
    buffer_load_dwordx4 a[44:47], v2, s[4:7], s63 offen offset:3072 sc1
    s_add_u32 s63, s24, 12288
    v_mfma_f32_16x16x32_bf16 v[56:59], a[200:203], v[16:19], v[56:59]
    ds_read_b64_tr_b16 a[128:129], v124 offset:12288
    v_mfma_f32_16x16x32_bf16 v[60:63], a[204:207], v[16:19], v[60:63]
    s_waitcnt lgkmcnt(7)
    ds_read_b64_tr_b16 a[130:131], v124 offset:14336
    s_barrier
    v_mfma_f32_16x16x32_bf16 v[48:51], a[208:211], v[20:23], v[48:51]
    buffer_load_dwordx4 a[48:51], v2, s[4:7], s63 offen offset:0 sc1
    v_mfma_f32_16x16x32_bf16 v[52:55], a[212:215], v[20:23], v[52:55]
    ds_read_b64_tr_b16 a[132:133], v125 offset:12288
    v_mfma_f32_16x16x32_bf16 v[56:59], a[216:219], v[20:23], v[56:59]
    ds_read_b64_tr_b16 a[134:135], v125 offset:14336
    v_mfma_f32_16x16x32_bf16 v[60:63], a[220:223], v[20:23], v[60:63]
    s_waitcnt lgkmcnt(7)
    buffer_load_dwordx4 a[52:55], v2, s[4:7], s63 offen offset:1024 sc1
    s_add_u32 s63, s24, 1835008
    v_mfma_f32_16x16x32_bf16 v[48:51], a[224:227], v[24:27], v[48:51]
    ds_read_b64_tr_b16 a[136:137], v126 offset:12288
    v_min_u32 v13, 13, v1
    v_mfma_f32_16x16x32_bf16 v[52:55], a[228:231], v[24:27], v[52:55]
    ds_read_b64_tr_b16 a[138:139], v126 offset:14336
    v_lshlrev_b32 v13, 7, v13
    v_mfma_f32_16x16x32_bf16 v[56:59], a[232:235], v[24:27], v[56:59]
    s_add_u32 s62, s25, 17301504
    buffer_load_dword v12, v13, s[4:7], s62 offen sc1
    v_mfma_f32_16x16x32_bf16 v[60:63], a[236:239], v[24:27], v[60:63]
    s_waitcnt lgkmcnt(6)
    buffer_load_dwordx4 a[56:59], v2, s[4:7], s63 offen offset:0 sc1
    v_mfma_f32_16x16x32_bf16 v[48:51], a[240:243], v[28:31], v[48:51]
    ds_read_b64_tr_b16 a[140:141], v127 offset:12288
    v_mfma_f32_16x16x32_bf16 v[52:55], a[244:247], v[28:31], v[52:55]
    ds_read_b64_tr_b16 a[142:143], v127 offset:14336
    v_mfma_f32_16x16x32_bf16 v[56:59], a[248:251], v[28:31], v[56:59]
    buffer_load_dwordx4 a[60:63], v2, s[4:7], s63 offen offset:1024 sc1
    v_mfma_f32_16x16x32_bf16 v[60:63], a[252:255], v[28:31], v[60:63]
    ds_read_b64_tr_b16 a[144:145], v124 offset:16384
L_gemm2:
    s_waitcnt vmcnt(17)
    v_mfma_f32_16x16x32_bf16 v[32:35], v[128:131], a[0:3], 0
    buffer_load_dwordx4 a[64:67], v2, s[4:7], s63 offen offset:2048 sc1
    v_mfma_f32_16x16x32_bf16 v[36:39], v[132:135], a[0:3], 0
    ds_read_b64_tr_b16 a[146:147], v124 offset:18432
    v_mfma_f32_16x16x32_bf16 v[40:43], v[136:139], a[0:3], 0
    ds_read_b64_tr_b16 a[148:149], v125 offset:16384
    v_mfma_f32_16x16x32_bf16 v[44:47], v[140:143], a[0:3], 0
    s_waitcnt vmcnt(17)
    buffer_load_dwordx4 a[68:71], v2, s[4:7], s63 offen offset:3072 sc1
    v_mul_f32 v48, v48, v56
    v_mfma_f32_16x16x32_bf16 v[32:35], v[144:147], a[4:7], v[32:35]
    s_add_u32 s63, s24, 1839104
    ds_read_b64_tr_b16 a[150:151], v125 offset:18432
    v_mul_f32 v49, v49, v57
    v_mfma_f32_16x16x32_bf16 v[36:39], v[148:151], a[4:7], v[36:39]
    ds_read_b64_tr_b16 a[152:153], v126 offset:16384
    v_mul_f32 v50, v50, v58
    v_mfma_f32_16x16x32_bf16 v[40:43], v[152:155], a[4:7], v[40:43]
    buffer_load_dwordx4 a[72:75], v2, s[4:7], s63 offen offset:0 sc1
    v_mul_f32 v51, v51, v59
    v_mfma_f32_16x16x32_bf16 v[44:47], v[156:159], a[4:7], v[44:47]
    s_waitcnt vmcnt(18)
    ds_read_b64_tr_b16 a[154:155], v126 offset:18432
    v_mul_f32 v52, v52, v60
    v_mfma_f32_16x16x32_bf16 v[32:35], v[160:163], a[8:11], v[32:35]
    ds_read_b64_tr_b16 a[156:157], v127 offset:16384
    v_mul_f32 v53, v53, v61
    v_mfma_f32_16x16x32_bf16 v[36:39], v[164:167], a[8:11], v[36:39]
    buffer_load_dwordx4 a[76:79], v2, s[4:7], s63 offen offset:1024 sc1
    v_mul_f32 v54, v54, v62
    v_mfma_f32_16x16x32_bf16 v[40:43], v[168:171], a[8:11], v[40:43]
    ds_read_b64_tr_b16 a[158:159], v127 offset:18432
    v_mul_f32 v55, v55, v63
    v_mfma_f32_16x16x32_bf16 v[44:47], v[172:175], a[8:11], v[44:47]
    s_waitcnt vmcnt(17)
    ds_read_b64_tr_b16 a[160:161], v124 offset:20480
    v_cvt_pk_bf16_f32 v112, v48, v49
    v_mfma_f32_16x16x32_bf16 v[32:35], v[176:179], a[12:15], v[32:35]
    buffer_load_dwordx4 a[80:83], v2, s[4:7], s63 offen offset:2048 sc1
    v_cvt_pk_bf16_f32 v113, v50, v51
    v_mfma_f32_16x16x32_bf16 v[36:39], v[180:183], a[12:15], v[36:39]
    ds_read_b64_tr_b16 a[162:163], v124 offset:22528
    v_cvt_pk_bf16_f32 v114, v52, v53
    v_mfma_f32_16x16x32_bf16 v[40:43], v[184:187], a[12:15], v[40:43]
    ds_read_b64_tr_b16 a[164:165], v125 offset:20480
    v_cvt_pk_bf16_f32 v115, v54, v55
    v_mfma_f32_16x16x32_bf16 v[44:47], v[188:191], a[12:15], v[44:47]
    s_waitcnt vmcnt(17)
    buffer_load_dwordx4 a[84:87], v2, s[4:7], s63 offen offset:3072 sc1
    v_min_u32 v112, s58, v112
    v_mfma_f32_16x16x32_bf16 v[32:35], v[192:195], a[16:19], v[32:35]
    s_add_u32 s63, s24, 1843200
    ds_read_b64_tr_b16 a[166:167], v125 offset:22528
    v_min_u32 v113, s58, v113
    v_mfma_f32_16x16x32_bf16 v[36:39], v[196:199], a[16:19], v[36:39]
    ds_read_b64_tr_b16 a[168:169], v126 offset:20480
    v_min_u32 v114, s58, v114
    v_mfma_f32_16x16x32_bf16 v[40:43], v[200:203], a[16:19], v[40:43]
    buffer_load_dwordx4 a[88:91], v2, s[4:7], s63 offen offset:0 sc1
    v_min_u32 v115, s58, v115
    v_mfma_f32_16x16x32_bf16 v[44:47], v[204:207], a[16:19], v[44:47]
    s_waitcnt vmcnt(18)
    buffer_store_dwordx4 v[112:115], v2, s[4:7], s65 offen sc1
    s_add_u32 s65, s65, 917504
    v_mfma_f32_16x16x32_bf16 v[32:35], v[208:211], a[20:23], v[32:35]
    ds_read_b64_tr_b16 a[170:171], v126 offset:22528
    v_mfma_f32_16x16x32_bf16 v[36:39], v[212:215], a[20:23], v[36:39]
    buffer_load_dwordx4 a[92:95], v2, s[4:7], s63 offen offset:1024 sc1
    v_mfma_f32_16x16x32_bf16 v[40:43], v[216:219], a[20:23], v[40:43]
    ds_read_b64_tr_b16 a[172:173], v127 offset:20480
    v_mfma_f32_16x16x32_bf16 v[44:47], v[220:223], a[20:23], v[44:47]
    s_waitcnt vmcnt(19)
    ds_read_b64_tr_b16 a[174:175], v127 offset:22528
    v_mfma_f32_16x16x32_bf16 v[32:35], v[224:227], a[24:27], v[32:35]
    buffer_load_dwordx4 a[96:99], v2, s[4:7], s63 offen offset:2048 sc1
    v_mfma_f32_16x16x32_bf16 v[36:39], v[228:231], a[24:27], v[36:39]
    ds_read_b64_tr_b16 a[176:177], v124 offset:0
    v_mfma_f32_16x16x32_bf16 v[40:43], v[232:235], a[24:27], v[40:43]
    ds_read_b64_tr_b16 a[178:179], v124 offset:2048
    v_mfma_f32_16x16x32_bf16 v[44:47], v[236:239], a[24:27], v[44:47]
    s_waitcnt vmcnt(19)
    buffer_load_dwordx4 a[100:103], v2, s[4:7], s63 offen offset:3072 sc1
    s_add_u32 s63, s24, 1847296
    v_mfma_f32_16x16x32_bf16 v[32:35], v[240:243], a[28:31], v[32:35]
    ds_read_b64_tr_b16 a[180:181], v125 offset:0
    v_mfma_f32_16x16x32_bf16 v[36:39], v[244:247], a[28:31], v[36:39]
    ds_read_b64_tr_b16 a[182:183], v125 offset:2048
    v_mfma_f32_16x16x32_bf16 v[40:43], v[248:251], a[28:31], v[40:43]
    buffer_load_dwordx4 a[104:107], v2, s[4:7], s63 offen offset:0 sc1
    v_mfma_f32_16x16x32_bf16 v[44:47], v[252:255], a[28:31], v[44:47]
    s_waitcnt vmcnt(20) lgkmcnt(15)
    ds_read_b64_tr_b16 a[184:185], v126 offset:0
    v_mfma_f32_16x16x32_bf16 v[32:35], a[112:115], a[32:35], v[32:35]
    ds_read_b64_tr_b16 a[186:187], v126 offset:2048
    v_mfma_f32_16x16x32_bf16 v[36:39], a[116:119], a[32:35], v[36:39]
    buffer_load_dwordx4 a[108:111], v2, s[4:7], s63 offen offset:1024 sc1
    v_mfma_f32_16x16x32_bf16 v[40:43], a[120:123], a[32:35], v[40:43]
    ds_read_b64_tr_b16 a[188:189], v127 offset:0
    v_mfma_f32_16x16x32_bf16 v[44:47], a[124:127], a[32:35], v[44:47]
    s_waitcnt vmcnt(20) lgkmcnt(15)
    ds_read_b64_tr_b16 a[190:191], v127 offset:2048
    v_mfma_f32_16x16x32_bf16 v[32:35], a[128:131], a[36:39], v[32:35]
    ds_read_b64_tr_b16 a[192:193], v124 offset:4096
    v_mfma_f32_16x16x32_bf16 v[36:39], a[132:135], a[36:39], v[36:39]
    ds_read_b64_tr_b16 a[194:195], v124 offset:6144
    v_mfma_f32_16x16x32_bf16 v[40:43], a[136:139], a[36:39], v[40:43]
    ds_read_b64_tr_b16 a[196:197], v125 offset:4096
    v_mfma_f32_16x16x32_bf16 v[44:47], a[140:143], a[36:39], v[44:47]
    s_waitcnt vmcnt(19) lgkmcnt(15)
    ds_read_b64_tr_b16 a[198:199], v125 offset:6144
    v_mfma_f32_16x16x32_bf16 v[32:35], a[144:147], a[40:43], v[32:35]
    s_waitcnt vmcnt(15)
    ds_read_b64_tr_b16 a[200:201], v126 offset:4096
    v_cmp_ne_u32 vcc, s56, v12
    v_mfma_f32_16x16x32_bf16 v[36:39], a[148:151], a[40:43], v[36:39]
    s_cbranch_vccnz L_slow19
L_back19:
    ds_read_b64_tr_b16 a[202:203], v126 offset:6144
    v_mfma_f32_16x16x32_bf16 v[40:43], a[152:155], a[40:43], v[40:43]
    s_add_u32 s63, s24, 3670016
    buffer_load_dwordx4 a[208:211], v2, s[4:7], s63 offen offset:0 sc1
    v_mfma_f32_16x16x32_bf16 v[44:47], a[156:159], a[40:43], v[44:47]
    s_waitcnt vmcnt(19) lgkmcnt(14)
    ds_read_b64_tr_b16 a[204:205], v127 offset:4096
    v_mfma_f32_16x16x32_bf16 v[32:35], a[160:163], a[44:47], v[32:35]
    ds_read_b64_tr_b16 a[206:207], v127 offset:6144
    v_mfma_f32_16x16x32_bf16 v[36:39], a[164:167], a[44:47], v[36:39]
    buffer_load_dwordx4 a[212:215], v2, s[4:7], s63 offen offset:1024 sc1
    v_mfma_f32_16x16x32_bf16 v[40:43], a[168:171], a[44:47], v[40:43]
    v_mfma_f32_16x16x32_bf16 v[44:47], a[172:175], a[44:47], v[44:47]
    s_waitcnt vmcnt(19) lgkmcnt(8)
    v_mfma_f32_16x16x32_bf16 v[32:35], a[176:179], a[48:51], v[32:35]
    buffer_load_dwordx4 a[216:219], v2, s[4:7], s63 offen offset:2048 sc1
    v_mfma_f32_16x16x32_bf16 v[36:39], a[180:183], a[48:51], v[36:39]
    v_mfma_f32_16x16x32_bf16 v[40:43], a[184:187], a[48:51], v[40:43]
    v_mfma_f32_16x16x32_bf16 v[44:47], a[188:191], a[48:51], v[44:47]
    s_waitcnt vmcnt(19) lgkmcnt(0)
    buffer_load_dwordx4 a[220:223], v2, s[4:7], s63 offen offset:3072 sc1
    s_add_u32 s63, s24, 3674112
    v_mfma_f32_16x16x32_bf16 v[32:35], a[192:195], a[52:55], v[32:35]
    v_mfma_f32_16x16x32_bf16 v[36:39], a[196:199], a[52:55], v[36:39]
    v_mfma_f32_16x16x32_bf16 v[40:43], a[200:203], a[52:55], v[40:43]
    buffer_load_dwordx4 a[224:227], v2, s[4:7], s63 offen offset:0 sc1
    v_mfma_f32_16x16x32_bf16 v[44:47], a[204:207], a[52:55], v[44:47]
    s_waitcnt vmcnt(19)
    v_mfma_f32_16x16x32_bf16 v[48:51], v[128:131], a[56:59], 0
    v_mfma_f32_16x16x32_bf16 v[52:55], v[132:135], a[56:59], 0
    buffer_load_dwordx4 a[228:231], v2, s[4:7], s63 offen offset:1024 sc1
    v_mfma_f32_16x16x32_bf16 v[56:59], v[136:139], a[56:59], 0
    v_mfma_f32_16x16x32_bf16 v[60:63], v[140:143], a[56:59], 0
    s_waitcnt vmcnt(19)
    ds_write_b128 v92, v[32:35] offset:0
    v_mfma_f32_16x16x32_bf16 v[48:51], v[144:147], a[60:63], v[48:51]
    ds_write_b128 v93, v[36:39] offset:0
    v_mfma_f32_16x16x32_bf16 v[52:55], v[148:151], a[60:63], v[52:55]
    ds_write_b128 v94, v[40:43] offset:0
    v_mfma_f32_16x16x32_bf16 v[56:59], v[152:155], a[60:63], v[56:59]
    ds_write_b128 v95, v[44:47] offset:0
    v_mfma_f32_16x16x32_bf16 v[60:63], v[156:159], a[60:63], v[60:63]
    s_waitcnt vmcnt(18)
    buffer_load_dwordx4 a[232:235], v2, s[4:7], s63 offen offset:2048 sc1
    v_mfma_f32_16x16x32_bf16 v[48:51], v[160:163], a[64:67], v[48:51]
    v_mfma_f32_16x16x32_bf16 v[52:55], v[164:167], a[64:67], v[52:55]
    v_mfma_f32_16x16x32_bf16 v[56:59], v[168:171], a[64:67], v[56:59]
    buffer_load_dwordx4 a[236:239], v2, s[4:7], s63 offen offset:3072 sc1
    s_add_u32 s63, s24, 3678208
    v_mfma_f32_16x16x32_bf16 v[60:63], v[172:175], a[64:67], v[60:63]
    s_waitcnt vmcnt(19)
    v_mfma_f32_16x16x32_bf16 v[48:51], v[176:179], a[68:71], v[48:51]
    s_waitcnt lgkmcnt(0)
    s_barrier
    v_mfma_f32_16x16x32_bf16 v[52:55], v[180:183], a[68:71], v[52:55]
    ds_read_b128 v[16:19], v10 offset:0
    v_mfma_f32_16x16x32_bf16 v[56:59], v[184:187], a[68:71], v[56:59]
    ds_read_b128 v[20:23], v10 offset:4096
    v_mfma_f32_16x16x32_bf16 v[60:63], v[188:191], a[68:71], v[60:63]
    s_waitcnt vmcnt(18)
    ds_read_b128 v[24:27], v10 offset:8192
    v_mfma_f32_16x16x32_bf16 v[48:51], v[192:195], a[72:75], v[48:51]
    ds_read_b128 v[28:31], v10 offset:12288
    v_lshlrev_b32 v32, 16, v80
    v_mfma_f32_16x16x32_bf16 v[52:55], v[196:199], a[72:75], v[52:55]
    buffer_load_dwordx4 a[240:243], v2, s[4:7], s63 offen offset:0 sc1
    v_and_b32 v33, s57, v80
    v_mfma_f32_16x16x32_bf16 v[56:59], v[200:203], a[72:75], v[56:59]
    v_lshlrev_b32 v34, 16, v81
    v_and_b32 v35, s57, v81
    v_mfma_f32_16x16x32_bf16 v[60:63], v[204:207], a[72:75], v[60:63]
    s_waitcnt vmcnt(18)
    v_mfma_f32_16x16x32_bf16 v[48:51], v[208:211], a[76:79], v[48:51]
    buffer_load_dwordx4 a[244:247], v2, s[4:7], s63 offen offset:1024 sc1
    v_mfma_f32_16x16x32_bf16 v[52:55], v[212:215], a[76:79], v[52:55]
    v_mfma_f32_16x16x32_bf16 v[56:59], v[216:219], a[76:79], v[56:59]
    v_mfma_f32_16x16x32_bf16 v[60:63], v[220:223], a[76:79], v[60:63]
    s_waitcnt vmcnt(18)
    buffer_load_dwordx4 a[248:251], v2, s[4:7], s63 offen offset:2048 sc1
    s_waitcnt lgkmcnt(0)
    v_mfma_f32_16x16x32_bf16 v[48:51], v[224:227], a[80:83], v[48:51]
    v_add_f32 v16, v16, v20
    v_add_f32 v24, v24, v28
    v_mfma_f32_16x16x32_bf16 v[52:55], v[228:231], a[80:83], v[52:55]
    v_add_f32 v17, v17, v21
    v_add_f32 v25, v25, v29
    v_mfma_f32_16x16x32_bf16 v[56:59], v[232:235], a[80:83], v[56:59]
    buffer_load_dwordx4 a[252:255], v2, s[4:7], s63 offen offset:3072 sc1
    v_add_f32 v18, v18, v22
    v_mfma_f32_16x16x32_bf16 v[60:63], v[236:239], a[80:83], v[60:63]
    s_waitcnt vmcnt(19)
    v_add_f32 v26, v26, v30
    v_add_f32 v19, v19, v23
    v_mfma_f32_16x16x32_bf16 v[48:51], v[240:243], a[84:87], v[48:51]
    s_add_u32 s63, s24, 3682304
    v_add_f32 v27, v27, v31
    v_add_f32 v16, v16, v24
    v_mfma_f32_16x16x32_bf16 v[52:55], v[244:247], a[84:87], v[52:55]
    buffer_load_dwordx4 a[0:3], v2, s[4:7], s63 offen offset:0 sc1
    v_add_f32 v17, v17, v25
    v_mfma_f32_16x16x32_bf16 v[56:59], v[248:251], a[84:87], v[56:59]
    v_add_f32 v18, v18, v26
    v_add_f32 v19, v19, v27
    v_mfma_f32_16x16x32_bf16 v[60:63], v[252:255], a[84:87], v[60:63]
    s_waitcnt vmcnt(19)
    v_fma_f32 v16, v16, v88, v32
    v_fma_f32 v17, v17, v89, v33
    v_mfma_f32_16x16x32_bf16 v[48:51], a[112:115], a[88:91], v[48:51]
    buffer_load_dwordx4 a[4:7], v2, s[4:7], s63 offen offset:1024 sc1
    v_fma_f32 v18, v18, v90, v34
    v_mfma_f32_16x16x32_bf16 v[52:55], a[116:119], a[88:91], v[52:55]
    s_add_u32 s63, s24, 5505024
    v_fma_f32 v19, v19, v91, v35
    v_cvt_pk_bf16_f32 v80, v16, v17
    v_mfma_f32_16x16x32_bf16 v[56:59], a[120:123], a[88:91], v[56:59]
    v_cvt_pk_bf16_f32 v81, v18, v19
    v_mfma_f32_16x16x32_bf16 v[60:63], a[124:127], a[88:91], v[60:63]
    s_waitcnt vmcnt(18)
    buffer_load_dwordx4 v[64:67], v2, s[4:7], s63 offen offset:0 sc1
    v_mfma_f32_16x16x32_bf16 v[48:51], a[128:131], a[92:95], v[48:51]
    v_mfma_f32_16x16x32_bf16 v[52:55], a[132:135], a[92:95], v[52:55]
    v_mfma_f32_16x16x32_bf16 v[56:59], a[136:139], a[92:95], v[56:59]
    buffer_load_dwordx4 v[68:71], v2, s[4:7], s63 offen offset:1024 sc1
    v_mfma_f32_16x16x32_bf16 v[60:63], a[140:143], a[92:95], v[60:63]
    s_waitcnt vmcnt(19)
    v_mfma_f32_16x16x32_bf16 v[48:51], a[144:147], a[96:99], v[48:51]
    v_mfma_f32_16x16x32_bf16 v[52:55], a[148:151], a[96:99], v[52:55]
    buffer_load_dwordx4 v[72:75], v2, s[4:7], s63 offen offset:2048 sc1
    v_mfma_f32_16x16x32_bf16 v[56:59], a[152:155], a[96:99], v[56:59]
    v_mfma_f32_16x16x32_bf16 v[60:63], a[156:159], a[96:99], v[60:63]
    s_waitcnt vmcnt(19)
    v_mfma_f32_16x16x32_bf16 v[48:51], a[160:163], a[100:103], v[48:51]
    buffer_load_dwordx4 v[76:79], v2, s[4:7], s63 offen offset:3072 sc1
    s_add_u32 s63, s24, 5509120
    v_mfma_f32_16x16x32_bf16 v[52:55], a[164:167], a[100:103], v[52:55]
    v_mfma_f32_16x16x32_bf16 v[56:59], a[168:171], a[100:103], v[56:59]
    v_mfma_f32_16x16x32_bf16 v[60:63], a[172:175], a[100:103], v[60:63]
    s_waitcnt vmcnt(19)
    buffer_load_dwordx4 v[96:99], v2, s[4:7], s63 offen offset:0 sc1
    v_mfma_f32_16x16x32_bf16 v[48:51], a[176:179], a[104:107], v[48:51]
    v_mfma_f32_16x16x32_bf16 v[52:55], a[180:183], a[104:107], v[52:55]
    v_mfma_f32_16x16x32_bf16 v[56:59], a[184:187], a[104:107], v[56:59]
    buffer_load_dwordx4 v[100:103], v2, s[4:7], s63 offen offset:1024 sc1
    v_mfma_f32_16x16x32_bf16 v[60:63], a[188:191], a[104:107], v[60:63]
    s_waitcnt vmcnt(20)
    v_mfma_f32_16x16x32_bf16 v[48:51], a[192:195], a[108:111], v[48:51]
    v_mfma_f32_16x16x32_bf16 v[52:55], a[196:199], a[108:111], v[52:55]
    buffer_load_dwordx4 v[104:107], v2, s[4:7], s63 offen offset:2048 sc1
    v_mfma_f32_16x16x32_bf16 v[56:59], a[200:203], a[108:111], v[56:59]
    v_mfma_f32_16x16x32_bf16 v[60:63], a[204:207], a[108:111], v[60:63]
    s_waitcnt vmcnt(20)
    v_mfma_f32_16x16x32_bf16 v[32:35], v[128:131], a[208:211], 0
    buffer_load_dwordx4 v[108:111], v2, s[4:7], s63 offen offset:3072 sc1
    s_add_u32 s63, s24, 5513216
    v_mfma_f32_16x16x32_bf16 v[36:39], v[132:135], a[208:211], 0
    v_mfma_f32_16x16x32_bf16 v[40:43], v[136:139], a[208:211], 0
    v_mfma_f32_16x16x32_bf16 v[44:47], v[140:143], a[208:211], 0
    s_waitcnt vmcnt(20)
    ds_write_b128 v92, v[48:51] offset:16384
    v_mfma_f32_16x16x32_bf16 v[32:35], v[144:147], a[212:215], v[32:35]
    ds_write_b128 v93, v[52:55] offset:16384
    v_mfma_f32_16x16x32_bf16 v[36:39], v[148:151], a[212:215], v[36:39]
    ds_write_b128 v94, v[56:59] offset:16384
    v_mfma_f32_16x16x32_bf16 v[40:43], v[152:155], a[212:215], v[40:43]
    ds_write_b128 v95, v[60:63] offset:16384
    v_mfma_f32_16x16x32_bf16 v[44:47], v[156:159], a[212:215], v[44:47]
    s_waitcnt vmcnt(19)
    buffer_load_dwordx4 v[4:7], v2, s[4:7], s63 offen offset:0 sc1
    v_mfma_f32_16x16x32_bf16 v[32:35], v[160:163], a[216:219], v[32:35]
    v_mfma_f32_16x16x32_bf16 v[36:39], v[164:167], a[216:219], v[36:39]
    v_mfma_f32_16x16x32_bf16 v[40:43], v[168:171], a[216:219], v[40:43]
    buffer_load_dwordx4 v[12:15], v2, s[4:7], s63 offen offset:1024 sc1
    v_mfma_f32_16x16x32_bf16 v[44:47], v[172:175], a[216:219], v[44:47]
    s_waitcnt vmcnt(20)
    v_mfma_f32_16x16x32_bf16 v[32:35], v[176:179], a[220:223], v[32:35]
    s_waitcnt lgkmcnt(0)
    s_barrier
    v_mfma_f32_16x16x32_bf16 v[36:39], v[180:183], a[220:223], v[36:39]
    ds_read_b128 v[16:19], v10 offset:16384
    v_mfma_f32_16x16x32_bf16 v[40:43], v[184:187], a[220:223], v[40:43]
    ds_read_b128 v[20:23], v10 offset:20480
    v_mfma_f32_16x16x32_bf16 v[44:47], v[188:191], a[220:223], v[44:47]
    s_waitcnt vmcnt(19)
    ds_read_b128 v[24:27], v10 offset:24576
    v_mfma_f32_16x16x32_bf16 v[32:35], v[192:195], a[224:227], v[32:35]
    s_waitcnt vmcnt(5)
    ds_read_b128 v[28:31], v10 offset:28672
    v_lshlrev_b32 v48, 16, v82
    v_mfma_f32_16x16x32_bf16 v[36:39], v[196:199], a[224:227], v[36:39]
    buffer_load_dwordx4 v[116:119], v2, s[4:7], s63 offen offset:2048 sc1
    v_and_b32 v49, s57, v82
    v_mfma_f32_16x16x32_bf16 v[40:43], v[200:203], a[224:227], v[40:43]
    v_lshlrev_b32 v50, 16, v83
    v_and_b32 v51, s57, v83
    v_mfma_f32_16x16x32_bf16 v[44:47], v[204:207], a[224:227], v[44:47]
    s_waitcnt vmcnt(19)
    v_max3_u32 v1, v64, v65, v66
    v_max3_u32 v1, v1, v67, v68
    v_mfma_f32_16x16x32_bf16 v[32:35], v[208:211], a[228:231], v[32:35]
    buffer_load_dwordx4 v[120:123], v2, s[4:7], s63 offen offset:3072 sc1
    v_max3_u32 v1, v1, v69, v70
    v_mfma_f32_16x16x32_bf16 v[36:39], v[212:215], a[228:231], v[36:39]
    s_add_u32 s63, s24, 5517312
    v_max3_u32 v1, v1, v71, v72
    v_max3_u32 v1, v1, v73, v74
    v_mfma_f32_16x16x32_bf16 v[40:43], v[216:219], a[228:231], v[40:43]
    v_max3_u32 v1, v1, v75, v76
    v_max3_u32 v1, v1, v77, v78
    v_mfma_f32_16x16x32_bf16 v[44:47], v[220:223], a[228:231], v[44:47]
    s_waitcnt vmcnt(19)
    buffer_load_dwordx4 v[112:115], v2, s[4:7], s63 offen offset:0 sc1
    v_max3_u32 v1, v1, v79, v96
    v_mfma_f32_16x16x32_bf16 v[32:35], v[224:227], a[232:235], v[32:35]
    s_waitcnt lgkmcnt(0)
    v_add_f32 v16, v16, v20
    v_add_f32 v24, v24, v28
    v_mfma_f32_16x16x32_bf16 v[36:39], v[228:231], a[232:235], v[36:39]
    v_add_f32 v17, v17, v21
    v_add_f32 v25, v25, v29
    v_mfma_f32_16x16x32_bf16 v[40:43], v[232:235], a[232:235], v[40:43]
    buffer_load_dwordx4 v[124:127], v2, s[4:7], s63 offen offset:1024 sc1
    v_add_f32 v18, v18, v22
    v_mfma_f32_16x16x32_bf16 v[44:47], v[236:239], a[232:235], v[44:47]
    s_waitcnt vmcnt(20)
    v_add_f32 v26, v26, v30
    v_add_f32 v19, v19, v23
    v_mfma_f32_16x16x32_bf16 v[32:35], v[240:243], a[236:239], v[32:35]
    v_add_f32 v27, v27, v31
    v_add_f32 v16, v16, v24
    v_mfma_f32_16x16x32_bf16 v[36:39], v[244:247], a[236:239], v[36:39]
    v_add_f32 v17, v17, v25
    v_add_f32 v18, v18, v26
    v_mfma_f32_16x16x32_bf16 v[40:43], v[248:251], a[236:239], v[40:43]
    v_add_f32 v19, v19, v27
    v_fma_f32 v16, v16, v88, v48
    v_mfma_f32_16x16x32_bf16 v[44:47], v[252:255], a[236:239], v[44:47]
    s_waitcnt vmcnt(19)
    v_fma_f32 v17, v17, v89, v49
    v_fma_f32 v18, v18, v90, v50
    v_mfma_f32_16x16x32_bf16 v[32:35], a[112:115], a[240:243], v[32:35]
    v_fma_f32 v19, v19, v91, v51
    v_cvt_pk_bf16_f32 v82, v16, v17
    v_mfma_f32_16x16x32_bf16 v[36:39], a[116:119], a[240:243], v[36:39]
    v_cvt_pk_bf16_f32 v83, v18, v19
    v_max3_u32 v1, v1, v97, v98
    v_mfma_f32_16x16x32_bf16 v[40:43], a[120:123], a[240:243], v[40:43]
    v_max_u32 v1, v1, v99
    v_cmp_eq_u32 vcc, -1, v1
    v_mfma_f32_16x16x32_bf16 v[44:47], a[124:127], a[240:243], v[44:47]
    s_waitcnt vmcnt(18)
    s_cbranch_vccnz L_slow20
L_back20:
    v_mfma_f32_16x16x32_bf16 v[32:35], a[128:131], a[244:247], v[32:35]
    v_mfma_f32_16x16x32_bf16 v[36:39], a[132:135], a[244:247], v[36:39]
    v_mfma_f32_16x16x32_bf16 v[40:43], a[136:139], a[244:247], v[40:43]
    v_mfma_f32_16x16x32_bf16 v[44:47], a[140:143], a[244:247], v[44:47]
    s_waitcnt vmcnt(17)
    v_mfma_f32_16x16x32_bf16 v[32:35], a[144:147], a[248:251], v[32:35]
    v_mfma_f32_16x16x32_bf16 v[36:39], a[148:151], a[248:251], v[36:39]
    v_mfma_f32_16x16x32_bf16 v[40:43], a[152:155], a[248:251], v[40:43]
    v_mfma_f32_16x16x32_bf16 v[44:47], a[156:159], a[248:251], v[44:47]
    s_waitcnt vmcnt(16)
    s_waitcnt vmcnt(4)
    v_max3_u32 v1, v100, v101, v102
    v_mfma_f32_16x16x32_bf16 v[32:35], a[160:163], a[252:255], v[32:35]
    v_max3_u32 v1, v1, v103, v104
    v_max3_u32 v1, v1, v105, v106
    v_mfma_f32_16x16x32_bf16 v[36:39], a[164:167], a[252:255], v[36:39]
    v_max3_u32 v1, v1, v107, v108
    v_max3_u32 v1, v1, v109, v110
    v_mfma_f32_16x16x32_bf16 v[40:43], a[168:171], a[252:255], v[40:43]
    v_max3_u32 v1, v1, v111, v4
    v_max3_u32 v1, v1, v5, v6
    v_mfma_f32_16x16x32_bf16 v[44:47], a[172:175], a[252:255], v[44:47]
    s_waitcnt vmcnt(15)
    v_max3_u32 v1, v1, v7, v12
    v_max3_u32 v1, v1, v13, v14
    v_mfma_f32_16x16x32_bf16 v[32:35], a[176:179], a[0:3], v[32:35]
    v_max_u32 v1, v1, v15
    v_cmp_eq_u32 vcc, -1, v1
    v_mfma_f32_16x16x32_bf16 v[36:39], a[180:183], a[0:3], v[36:39]
    s_cbranch_vccnz L_slow21
L_back21:
    v_mfma_f32_16x16x32_bf16 v[40:43], a[184:187], a[0:3], v[40:43]
    v_mfma_f32_16x16x32_bf16 v[44:47], a[188:191], a[0:3], v[44:47]
    s_waitcnt vmcnt(14)
    v_mfma_f32_16x16x32_bf16 v[32:35], a[192:195], a[4:7], v[32:35]
    v_mfma_f32_16x16x32_bf16 v[36:39], a[196:199], a[4:7], v[36:39]
    v_mfma_f32_16x16x32_bf16 v[40:43], a[200:203], a[4:7], v[40:43]
    v_mfma_f32_16x16x32_bf16 v[44:47], a[204:207], a[4:7], v[44:47]
    s_waitcnt vmcnt(0)
    v_max3_u32 v1, v116, v117, v118
    v_max3_u32 v1, v1, v119, v120
    v_max3_u32 v1, v1, v121, v122
    v_max3_u32 v1, v1, v123, v112
    v_max3_u32 v1, v1, v113, v114
    v_max3_u32 v1, v1, v115, v124
    v_max3_u32 v1, v1, v125, v126
    v_max_u32 v1, v1, v127
    v_cmp_eq_u32 vcc, -1, v1
    s_nop 0
    s_cbranch_vccnz L_slow22
L_back22:
    v_mfma_f32_16x16x32_bf16 v[48:51], v[128:131], v[64:67], 0
    s_add_u32 s63, s71, 0
    buffer_store_dwordx2 v[80:81], v11, s[8:11], s63 offen sc1
    s_add_u32 s63, s71, 524288
    v_mfma_f32_16x16x32_bf16 v[48:51], v[144:147], v[68:71], v[48:51]
    v_mfma_f32_16x16x32_bf16 v[48:51], v[160:163], v[72:75], v[48:51]
    v_mfma_f32_16x16x32_bf16 v[48:51], v[176:179], v[76:79], v[48:51]
    ds_write_b128 v92, v[32:35] offset:0
    v_mfma_f32_16x16x32_bf16 v[48:51], v[192:195], v[96:99], v[48:51]
    ds_write_b128 v93, v[36:39] offset:0
    v_mfma_f32_16x16x32_bf16 v[48:51], v[208:211], v[100:103], v[48:51]
    ds_write_b128 v94, v[40:43] offset:0
    v_mfma_f32_16x16x32_bf16 v[48:51], v[224:227], v[104:107], v[48:51]
    ds_write_b128 v95, v[44:47] offset:0
    v_mfma_f32_16x16x32_bf16 v[48:51], v[240:243], v[108:111], v[48:51]
    buffer_store_dwordx2 v[82:83], v11, s[8:11], s63 offen sc1
    v_mfma_f32_16x16x32_bf16 v[48:51], a[112:115], v[4:7], v[48:51]
    v_mfma_f32_16x16x32_bf16 v[48:51], a[128:131], v[12:15], v[48:51]
    v_mfma_f32_16x16x32_bf16 v[48:51], a[144:147], v[116:119], v[48:51]
    v_mfma_f32_16x16x32_bf16 v[48:51], a[160:163], v[120:123], v[48:51]
    v_mfma_f32_16x16x32_bf16 v[48:51], a[176:179], v[112:115], v[48:51]
    s_waitcnt lgkmcnt(0)
    s_barrier
    v_mfma_f32_16x16x32_bf16 v[48:51], a[192:195], v[124:127], v[48:51]
    ds_read_b128 v[16:19], v10 offset:0
    v_mfma_f32_16x16x32_bf16 v[52:55], v[132:135], v[64:67], 0
    ds_read_b128 v[20:23], v10 offset:4096
    v_mfma_f32_16x16x32_bf16 v[52:55], v[148:151], v[68:71], v[52:55]
    ds_read_b128 v[24:27], v10 offset:8192
    v_mfma_f32_16x16x32_bf16 v[52:55], v[164:167], v[72:75], v[52:55]
    ds_read_b128 v[28:31], v10 offset:12288
    v_lshlrev_b32 v32, 16, v84
    v_mfma_f32_16x16x32_bf16 v[52:55], v[180:183], v[76:79], v[52:55]
    v_and_b32 v33, s57, v84
    v_lshlrev_b32 v34, 16, v85
    v_mfma_f32_16x16x32_bf16 v[52:55], v[196:199], v[96:99], v[52:55]
    v_and_b32 v35, s57, v85
    v_mfma_f32_16x16x32_bf16 v[52:55], v[212:215], v[100:103], v[52:55]
    v_mfma_f32_16x16x32_bf16 v[52:55], v[228:231], v[104:107], v[52:55]
    v_mfma_f32_16x16x32_bf16 v[52:55], v[244:247], v[108:111], v[52:55]
    v_mfma_f32_16x16x32_bf16 v[52:55], a[116:119], v[4:7], v[52:55]
    s_waitcnt lgkmcnt(0)
    v_add_f32 v16, v16, v20
    v_add_f32 v24, v24, v28
    v_mfma_f32_16x16x32_bf16 v[52:55], a[132:135], v[12:15], v[52:55]
    v_add_f32 v17, v17, v21
    v_add_f32 v25, v25, v29
    v_mfma_f32_16x16x32_bf16 v[52:55], a[148:151], v[116:119], v[52:55]
    v_add_f32 v18, v18, v22
    v_add_f32 v26, v26, v30
    v_mfma_f32_16x16x32_bf16 v[52:55], a[164:167], v[120:123], v[52:55]
    v_add_f32 v19, v19, v23
    v_add_f32 v27, v27, v31
    v_mfma_f32_16x16x32_bf16 v[52:55], a[180:183], v[112:115], v[52:55]
    v_add_f32 v16, v16, v24
    v_add_f32 v17, v17, v25
    v_mfma_f32_16x16x32_bf16 v[52:55], a[196:199], v[124:127], v[52:55]
    v_add_f32 v18, v18, v26
    v_add_f32 v19, v19, v27
    v_mfma_f32_16x16x32_bf16 v[56:59], v[136:139], v[64:67], 0
    v_fma_f32 v16, v16, v88, v32
    v_fma_f32 v17, v17, v89, v33
    v_mfma_f32_16x16x32_bf16 v[56:59], v[152:155], v[68:71], v[56:59]
    v_fma_f32 v18, v18, v90, v34
    v_fma_f32 v19, v19, v91, v35
    v_mfma_f32_16x16x32_bf16 v[56:59], v[168:171], v[72:75], v[56:59]
    v_cvt_pk_bf16_f32 v84, v16, v17
    v_cvt_pk_bf16_f32 v85, v18, v19
    v_mfma_f32_16x16x32_bf16 v[56:59], v[184:187], v[76:79], v[56:59]
    s_add_u32 s60, s71, 1048576
    buffer_store_dwordx2 v[84:85], v11, s[8:11], s60 offen sc1
    v_mfma_f32_16x16x32_bf16 v[56:59], v[200:203], v[96:99], v[56:59]
    ds_write_b128 v92, v[48:51] offset:16384
    v_mfma_f32_16x16x32_bf16 v[56:59], v[216:219], v[100:103], v[56:59]
    ds_write_b128 v93, v[52:55] offset:16384
    v_mfma_f32_16x16x32_bf16 v[56:59], v[232:235], v[104:107], v[56:59]
    v_mfma_f32_16x16x32_bf16 v[56:59], v[248:251], v[108:111], v[56:59]
    v_mfma_f32_16x16x32_bf16 v[56:59], a[120:123], v[4:7], v[56:59]
    v_mfma_f32_16x16x32_bf16 v[56:59], a[136:139], v[12:15], v[56:59]
    v_mfma_f32_16x16x32_bf16 v[56:59], a[152:155], v[116:119], v[56:59]
    v_mfma_f32_16x16x32_bf16 v[56:59], a[168:171], v[120:123], v[56:59]
    v_mfma_f32_16x16x32_bf16 v[56:59], a[184:187], v[112:115], v[56:59]
    v_mfma_f32_16x16x32_bf16 v[56:59], a[200:203], v[124:127], v[56:59]
    v_mfma_f32_16x16x32_bf16 v[60:63], v[140:143], v[64:67], 0
    v_mfma_f32_16x16x32_bf16 v[60:63], v[156:159], v[68:71], v[60:63]
    v_mfma_f32_16x16x32_bf16 v[60:63], v[172:175], v[72:75], v[60:63]
    v_mfma_f32_16x16x32_bf16 v[60:63], v[188:191], v[76:79], v[60:63]
    s_nop 3
    ds_write_b128 v94, v[56:59] offset:16384
    v_mfma_f32_16x16x32_bf16 v[60:63], v[204:207], v[96:99], v[60:63]
    v_mfma_f32_16x16x32_bf16 v[60:63], v[220:223], v[100:103], v[60:63]
    v_mfma_f32_16x16x32_bf16 v[60:63], v[236:239], v[104:107], v[60:63]
    v_mfma_f32_16x16x32_bf16 v[60:63], v[252:255], v[108:111], v[60:63]
    v_mfma_f32_16x16x32_bf16 v[60:63], a[124:127], v[4:7], v[60:63]
    v_mfma_f32_16x16x32_bf16 v[60:63], a[140:143], v[12:15], v[60:63]
    v_mfma_f32_16x16x32_bf16 v[60:63], a[156:159], v[116:119], v[60:63]
    v_mfma_f32_16x16x32_bf16 v[60:63], a[172:175], v[120:123], v[60:63]
    v_mfma_f32_16x16x32_bf16 v[60:63], a[188:191], v[112:115], v[60:63]
    v_mfma_f32_16x16x32_bf16 v[60:63], a[204:207], v[124:127], v[60:63]
    s_nop 7
    ds_write_b128 v95, v[60:63] offset:16384
    s_waitcnt lgkmcnt(0)
    s_barrier
    ds_read_b128 v[16:19], v10 offset:16384
    ds_read_b128 v[20:23], v10 offset:20480
    ds_read_b128 v[24:27], v10 offset:24576
    ds_read_b128 v[28:31], v10 offset:28672
    v_lshlrev_b32 v48, 16, v86
    v_and_b32 v49, s57, v86
    v_lshlrev_b32 v50, 16, v87
    v_and_b32 v51, s57, v87
    s_waitcnt lgkmcnt(0)
    v_pk_add_f32 v[16:17], v[16:17], v[20:21]
    v_pk_add_f32 v[24:25], v[24:25], v[28:29]
    v_pk_add_f32 v[18:19], v[18:19], v[22:23]
    v_pk_add_f32 v[26:27], v[26:27], v[30:31]
    v_pk_add_f32 v[16:17], v[16:17], v[24:25]
    v_pk_add_f32 v[18:19], v[18:19], v[26:27]
    v_pk_fma_f32 v[16:17], v[16:17], v[88:89], v[48:49]
    v_pk_fma_f32 v[18:19], v[18:19], v[90:91], v[50:51]
    v_cvt_pk_bf16_f32 v86, v16, v17
    v_cvt_pk_bf16_f32 v87, v18, v19
    s_add_u32 s60, s71, 1572864
    buffer_store_dwordx2 v[86:87], v11, s[8:11], s60 offen sc1
L_end:
    s_endpgm
L_spare:
    s_waitcnt vmcnt(0)
    v_max3_u32 v14, v156, v157, v158
    v_max_u32 v14, v14, v159
    v_cmp_eq_u32 vcc, -1, v14
    s_nop 0
    s_cbranch_vccnz L_slow23
L_back23:
    ds_write2st64_b32 v152, v156, v157 offset0:0 offset1:4
    ds_write2st64_b32 v152, v158, v159 offset0:8 offset1:12
    s_waitcnt lgkmcnt(0)
    s_barrier
    ds_read_b128 v[156:159], v153
    s_waitcnt lgkmcnt(0)
    v_mov_b32 v172, 0
    v_mov_b32 v173, 0
    v_lshlrev_b32 v160, 16, v156
    v_and_b32 v161, s57, v156
    v_lshlrev_b32 v162, 16, v157
    v_and_b32 v163, s57, v157
    v_lshlrev_b32 v164, 16, v158
    v_and_b32 v165, s57, v158
    v_lshlrev_b32 v166, 16, v159
    v_and_b32 v167, s57, v159
    v_pk_fma_f32 v[160:161], v[160:161], v[248:249], v[228:229]
    v_pk_fma_f32 v[162:163], v[162:163], v[250:251], v[230:231]
    v_pk_fma_f32 v[164:165], v[164:165], v[252:253], v[232:233]
    v_pk_fma_f32 v[166:167], v[166:167], v[254:255], v[234:235]
    v_cvt_pk_bf16_f32 v188, v160, v161
    v_cvt_pk_bf16_f32 v189, v162, v163
    v_cvt_pk_bf16_f32 v190, v164, v165
    v_cvt_pk_bf16_f32 v191, v166, v167
    v_dot2c_f32_bf16 v172, s67, v188
    v_dot2c_f32_bf16 v173, v188, v188
    v_dot2c_f32_bf16 v172, s67, v189
    v_dot2c_f32_bf16 v173, v189, v189
    v_dot2c_f32_bf16 v172, s67, v190
    v_dot2c_f32_bf16 v173, v190, v190
    v_dot2c_f32_bf16 v172, s67, v191
    v_dot2c_f32_bf16 v173, v191, v191
    s_add_u32 s66, s68, 5242880
    s_nop 0
    v_add_f32_dpp v172, v172, v172 quad_perm:[1,0,3,2] row_mask:0xf bank_mask:0xf
    v_add_f32_dpp v173, v173, v173 quad_perm:[1,0,3,2] row_mask:0xf bank_mask:0xf
    s_nop 0
    v_add_f32_dpp v172, v172, v172 quad_perm:[2,3,0,1] row_mask:0xf bank_mask:0xf
    v_add_f32_dpp v173, v173, v173 quad_perm:[2,3,0,1] row_mask:0xf bank_mask:0xf
    s_nop 0
    v_add_f32_dpp v172, v172, v172 row_half_mirror row_mask:0xf bank_mask:0xf
    v_add_f32_dpp v173, v173, v173 row_half_mirror row_mask:0xf bank_mask:0xf
    s_nop 0
    v_add_f32_dpp v172, v172, v172 row_mirror row_mask:0xf bank_mask:0xf
    v_add_f32_dpp v173, v173, v173 row_mirror row_mask:0xf bank_mask:0xf
    s_nop 0
    v_add_f32_dpp v172, v172, v172 row_bcast:15 row_mask:0xa bank_mask:0xf
    v_add_f32_dpp v173, v173, v173 row_bcast:15 row_mask:0xa bank_mask:0xf
    s_nop 0
    v_add_f32_dpp v172, v172, v172 row_bcast:31 row_mask:0xc bank_mask:0xf
    v_add_f32_dpp v173, v173, v173 row_bcast:31 row_mask:0xc bank_mask:0xf
    v_mul_f32 v172, 0x3b000000, v172
    v_mul_f32 v173, 0x3b000000, v173
    v_fma_f32 v173, -v172, v172, v173
    v_max_f32 v173, 0, v173
    v_cvt_pk_bf16_f32 v174, v173, v172
    v_lshlrev_b32 v173, 16, v174
    v_and_b32 v172, s57, v174
    v_add_f32 v173, 0x3727c5ac, v173
    v_cvt_pk_bf16_f32 v174, v173, v173
    v_lshlrev_b32 v173, 16, v174
    v_sqrt_f32 v173, v173
    s_nop 0
    v_cvt_pk_bf16_f32 v174, v173, v173
    v_lshlrev_b32 v173, 16, v174
    v_rcp_f32 v173, v173
    s_nop 0
    v_mul_f32 v172, -v172, v173
    v_readlane_b32 s72, v173, 63
    v_readlane_b32 s73, v172, 63
    s_nop 1
    v_mov_b32 v172, s73
    v_pk_fma_f32 v[160:161], v[160:161], s[72:73], v[172:173] op_sel_hi:[1,0,0]
    v_pk_fma_f32 v[162:163], v[162:163], s[72:73], v[172:173] op_sel_hi:[1,0,0]
    v_pk_fma_f32 v[164:165], v[164:165], s[72:73], v[172:173] op_sel_hi:[1,0,0]
    v_pk_fma_f32 v[166:167], v[166:167], s[72:73], v[172:173] op_sel_hi:[1,0,0]
    v_pk_fma_f32 v[160:161], v[160:161], v[80:81], v[88:89]
    v_pk_fma_f32 v[162:163], v[162:163], v[82:83], v[90:91]
    v_pk_fma_f32 v[164:165], v[164:165], v[84:85], v[92:93]
    v_pk_fma_f32 v[166:167], v[166:167], v[86:87], v[94:95]
    v_cvt_pk_bf16_f32 v168, v160, v161
    v_cvt_pk_bf16_f32 v169, v162, v163
    v_cvt_pk_bf16_f32 v170, v164, v165
    v_cvt_pk_bf16_f32 v171, v166, v167
    v_min_u32 v168, s58, v168
    v_min_u32 v169, s58, v169
    v_min_u32 v170, s58, v170
    v_min_u32 v171, s58, v171
    buffer_store_dwordx4 v[168:171], v2, s[4:7], s66 offen sc1
    s_add_u32 s60, s68, 6291456
    buffer_store_dwordx4 v[176:179], v2, s[4:7], s60 offen sc1
    s_add_u32 s60, s60, 0x100000
    buffer_store_dwordx4 v[188:191], v2, s[4:7], s60 offen sc1
    s_waitcnt vmcnt(0)
    s_barrier
    s_add_u32 s60, s64, 17104896
    v_lshlrev_b32 v7, 26, v6
    v_lshl_add_u32 v7, v5, 2, v7
    v_mov_b32 v9, s56
    buffer_store_dword v9, v7, s[4:7], s60 offen sc1
    s_add_u32 m0, s19, 0
    s_nop 0
    buffer_load_dwordx4 v116, s[48:51], s18 offen offset:0 lds
    buffer_load_dwordx4 v117, s[48:51], s18 offen offset:1024 lds
    buffer_load_dwordx4 v118, s[48:51], s18 offen offset:2048 lds
    buffer_load_dwordx4 v119, s[48:51], s18 offen offset:3072 lds
    s_add_u32 s18, s18, 32768
    s_add_u32 m0, s19, 4096
    s_nop 0
    buffer_load_dwordx4 v116, s[48:51], s18 offen offset:0 lds
    buffer_load_dwordx4 v117, s[48:51], s18 offen offset:1024 lds
    buffer_load_dwordx4 v118, s[48:51], s18 offen offset:2048 lds
    buffer_load_dwordx4 v119, s[48:51], s18 offen offset:3072 lds
    s_add_u32 s18, s18, 32768
    s_add_u32 m0, s19, 8192
    s_nop 0
    buffer_load_dwordx4 v116, s[48:51], s18 offen offset:0 lds
    buffer_load_dwordx4 v117, s[48:51], s18 offen offset:1024 lds
    buffer_load_dwordx4 v118, s[48:51], s18 offen offset:2048 lds
    buffer_load_dwordx4 v119, s[48:51], s18 offen offset:3072 lds
    s_add_u32 s18, s18, 32768
    s_add_u32 m0, s19, 12288
    s_nop 0
    buffer_load_dwordx4 v116, s[48:51], s18 offen offset:0 lds
    buffer_load_dwordx4 v117, s[48:51], s18 offen offset:1024 lds
    buffer_load_dwordx4 v118, s[48:51], s18 offen offset:2048 lds
    buffer_load_dwordx4 v119, s[48:51], s18 offen offset:3072 lds
    s_add_u32 s18, s18, 32768
    s_add_u32 m0, s19, 16384
    s_nop 0
    buffer_load_dwordx4 v116, s[48:51], s18 offen offset:0 lds
    buffer_load_dwordx4 v117, s[48:51], s18 offen offset:1024 lds
    buffer_load_dwordx4 v118, s[48:51], s18 offen offset:2048 lds
    buffer_load_dwordx4 v119, s[48:51], s18 offen offset:3072 lds
    s_add_u32 s18, s18, 32768
    s_add_u32 m0, s19, 20480
    s_nop 0
    buffer_load_dwordx4 v116, s[48:51], s18 offen offset:0 lds
    buffer_load_dwordx4 v117, s[48:51], s18 offen offset:1024 lds
    buffer_load_dwordx4 v118, s[48:51], s18 offen offset:2048 lds
    buffer_load_dwordx4 v119, s[48:51], s18 offen offset:3072 lds
    s_add_u32 s18, s18, 32768
    s_waitcnt vmcnt(0)
    ds_read_b64_tr_b16 v[128:129], v124 offset:0
    ds_read_b64_tr_b16 v[130:131], v124 offset:2048
    ds_read_b64_tr_b16 v[132:133], v125 offset:0
    ds_read_b64_tr_b16 v[134:135], v125 offset:2048
    ds_read_b64_tr_b16 v[136:137], v126 offset:0
    ds_read_b64_tr_b16 v[138:139], v126 offset:2048
    ds_read_b64_tr_b16 v[140:141], v127 offset:0
    ds_read_b64_tr_b16 v[142:143], v127 offset:2048
    ds_read_b64_tr_b16 v[144:145], v124 offset:4096
    ds_read_b64_tr_b16 v[146:147], v124 offset:6144
    ds_read_b64_tr_b16 v[148:149], v125 offset:4096
    ds_read_b64_tr_b16 v[150:151], v125 offset:6144
    ds_read_b64_tr_b16 v[152:153], v126 offset:4096
    ds_read_b64_tr_b16 v[154:155], v126 offset:6144
    ds_read_b64_tr_b16 v[156:157], v127 offset:4096
    ds_read_b64_tr_b16 v[158:159], v127 offset:6144
    ds_read_b64_tr_b16 v[160:161], v124 offset:8192
    ds_read_b64_tr_b16 v[162:163], v124 offset:10240
    ds_read_b64_tr_b16 v[164:165], v125 offset:8192
    ds_read_b64_tr_b16 v[166:167], v125 offset:10240
    ds_read_b64_tr_b16 v[168:169], v126 offset:8192
    ds_read_b64_tr_b16 v[170:171], v126 offset:10240
    ds_read_b64_tr_b16 v[172:173], v127 offset:8192
    ds_read_b64_tr_b16 v[174:175], v127 offset:10240
    ds_read_b64_tr_b16 v[176:177], v124 offset:12288
    ds_read_b64_tr_b16 v[178:179], v124 offset:14336
    ds_read_b64_tr_b16 v[180:181], v125 offset:12288
    ds_read_b64_tr_b16 v[182:183], v125 offset:14336
    ds_read_b64_tr_b16 v[184:185], v126 offset:12288
    ds_read_b64_tr_b16 v[186:187], v126 offset:14336
    ds_read_b64_tr_b16 v[188:189], v127 offset:12288
    ds_read_b64_tr_b16 v[190:191], v127 offset:14336
    ds_read_b64_tr_b16 v[192:193], v124 offset:16384
    ds_read_b64_tr_b16 v[194:195], v124 offset:18432
    ds_read_b64_tr_b16 v[196:197], v125 offset:16384
    ds_read_b64_tr_b16 v[198:199], v125 offset:18432
    ds_read_b64_tr_b16 v[200:201], v126 offset:16384
    ds_read_b64_tr_b16 v[202:203], v126 offset:18432
    ds_read_b64_tr_b16 v[204:205], v127 offset:16384
    ds_read_b64_tr_b16 v[206:207], v127 offset:18432
    ds_read_b64_tr_b16 v[208:209], v124 offset:20480
    ds_read_b64_tr_b16 v[210:211], v124 offset:22528
    ds_read_b64_tr_b16 v[212:213], v125 offset:20480
    ds_read_b64_tr_b16 v[214:215], v125 offset:22528
    ds_read_b64_tr_b16 v[216:217], v126 offset:20480
    ds_read_b64_tr_b16 v[218:219], v126 offset:22528
    ds_read_b64_tr_b16 v[220:221], v127 offset:20480
    ds_read_b64_tr_b16 v[222:223], v127 offset:22528
    s_waitcnt lgkmcnt(0)
    s_add_u32 m0, s19, 0
    s_nop 0
    buffer_load_dwordx4 v116, s[48:51], s18 offen offset:0 lds
    buffer_load_dwordx4 v117, s[48:51], s18 offen offset:1024 lds
    buffer_load_dwordx4 v118, s[48:51], s18 offen offset:2048 lds
    buffer_load_dwordx4 v119, s[48:51], s18 offen offset:3072 lds
    s_add_u32 s18, s18, 32768
    s_add_u32 m0, s19, 4096
    s_nop 0
    buffer_load_dwordx4 v116, s[48:51], s18 offen offset:0 lds
    buffer_load_dwordx4 v117, s[48:51], s18 offen offset:1024 lds
    buffer_load_dwordx4 v118, s[48:51], s18 offen offset:2048 lds
    buffer_load_dwordx4 v119, s[48:51], s18 offen offset:3072 lds
    s_add_u32 s18, s18, 32768
    s_add_u32 m0, s19, 8192
    s_nop 0
    buffer_load_dwordx4 v116, s[48:51], s18 offen offset:0 lds
    buffer_load_dwordx4 v117, s[48:51], s18 offen offset:1024 lds
    buffer_load_dwordx4 v118, s[48:51], s18 offen offset:2048 lds
    buffer_load_dwordx4 v119, s[48:51], s18 offen offset:3072 lds
    s_add_u32 s18, s18, 32768
    s_add_u32 m0, s19, 12288
    s_nop 0
    buffer_load_dwordx4 v116, s[48:51], s18 offen offset:0 lds
    buffer_load_dwordx4 v117, s[48:51], s18 offen offset:1024 lds
    buffer_load_dwordx4 v118, s[48:51], s18 offen offset:2048 lds
    buffer_load_dwordx4 v119, s[48:51], s18 offen offset:3072 lds
    s_add_u32 s18, s18, 32768
    s_add_u32 m0, s19, 16384
    s_nop 0
    buffer_load_dwordx4 v116, s[48:51], s18 offen offset:0 lds
    buffer_load_dwordx4 v117, s[48:51], s18 offen offset:1024 lds
    buffer_load_dwordx4 v118, s[48:51], s18 offen offset:2048 lds
    buffer_load_dwordx4 v119, s[48:51], s18 offen offset:3072 lds
    s_add_u32 s18, s18, 32768
    s_add_u32 m0, s19, 20480
    s_nop 0
    buffer_load_dwordx4 v116, s[48:51], s18 offen offset:0 lds
    buffer_load_dwordx4 v117, s[48:51], s18 offen offset:1024 lds
    buffer_load_dwordx4 v118, s[48:51], s18 offen offset:2048 lds
    buffer_load_dwordx4 v119, s[48:51], s18 offen offset:3072 lds
    s_add_u32 s18, s18, 32768
    s_waitcnt vmcnt(0)
    ds_read_b64_tr_b16 v[224:225], v124 offset:0
    ds_read_b64_tr_b16 v[226:227], v124 offset:2048
    ds_read_b64_tr_b16 v[228:229], v125 offset:0
    ds_read_b64_tr_b16 v[230:231], v125 offset:2048
    ds_read_b64_tr_b16 v[232:233], v126 offset:0
    ds_read_b64_tr_b16 v[234:235], v126 offset:2048
    ds_read_b64_tr_b16 v[236:237], v127 offset:0
    ds_read_b64_tr_b16 v[238:239], v127 offset:2048
    ds_read_b64_tr_b16 v[240:241], v124 offset:4096
    ds_read_b64_tr_b16 v[242:243], v124 offset:6144
    ds_read_b64_tr_b16 v[244:245], v125 offset:4096
    ds_read_b64_tr_b16 v[246:247], v125 offset:6144
    ds_read_b64_tr_b16 v[248:249], v126 offset:4096
    ds_read_b64_tr_b16 v[250:251], v126 offset:6144
    ds_read_b64_tr_b16 v[252:253], v127 offset:4096
    ds_read_b64_tr_b16 v[254:255], v127 offset:6144
    s_waitcnt lgkmcnt(0)
    s_add_u32 m0, s19, 0
    s_nop 0
    buffer_load_dwordx4 v116, s[48:51], s18 offen offset:0 lds
    buffer_load_dwordx4 v117, s[48:51], s18 offen offset:1024 lds
    buffer_load_dwordx4 v118, s[48:51], s18 offen offset:2048 lds
    buffer_load_dwordx4 v119, s[48:51], s18 offen offset:3072 lds
    s_add_u32 s18, s18, 32768
    s_add_u32 m0, s19, 4096
    s_nop 0
    buffer_load_dwordx4 v116, s[48:51], s18 offen offset:0 lds
    buffer_load_dwordx4 v117, s[48:51], s18 offen offset:1024 lds
    buffer_load_dwordx4 v118, s[48:51], s18 offen offset:2048 lds
    buffer_load_dwordx4 v119, s[48:51], s18 offen offset:3072 lds
    s_add_u32 s18, s18, 32768
    s_waitcnt vmcnt(0)
    s_waitcnt lgkmcnt(0)
    ds_read_b64_tr_b16 a[112:113], v124 offset:8192
    ds_read_b64_tr_b16 a[114:115], v124 offset:10240
    ds_read_b64_tr_b16 a[116:117], v125 offset:8192
    ds_read_b64_tr_b16 a[118:119], v125 offset:10240
    ds_read_b64_tr_b16 a[120:121], v126 offset:8192
    ds_read_b64_tr_b16 a[122:123], v126 offset:10240
    ds_read_b64_tr_b16 a[124:125], v127 offset:8192
    ds_read_b64_tr_b16 a[126:127], v127 offset:10240
    ds_read_b64_tr_b16 a[128:129], v124 offset:12288
    ds_read_b64_tr_b16 a[130:131], v124 offset:14336
    ds_read_b64_tr_b16 a[132:133], v125 offset:12288
    ds_read_b64_tr_b16 a[134:135], v125 offset:14336
    ds_read_b64_tr_b16 a[136:137], v126 offset:12288
    ds_read_b64_tr_b16 a[138:139], v126 offset:14336
    ds_read_b64_tr_b16 a[140:141], v127 offset:12288
    ds_read_b64_tr_b16 a[142:143], v127 offset:14336
    ds_read_b64_tr_b16 a[144:145], v124 offset:16384
    s_sleep 1
    s_mov_b32 s8, s40
    s_mov_b32 s9, s41
    s_mov_b32 s10, 0x200000
    s_mov_b32 s11, 0x20000
    v_lshrrev_b32 v96, 4, v0
    v_lshlrev_b32 v11, 10, v96
    v_lshl_add_u32 v11, v5, 3, v11
    v_lshrrev_b32 v97, 2, v5
    v_lshlrev_b32 v97, 3, v97
    v_and_b32 v98, 3, v5
    v_add_lshl_u32 v97, v97, v98, 3
    s_lshl_b32 s72, s17, 14
    s_lshl_b32 s73, s16, 7
    s_add_u32 s71, s72, s73
    s_lshl_b32 s73, s16, 8
    s_add_u32 s66, s73, 16787456
    v_xor_b32 v98, v6, v5
    v_lshlrev_b32 v98, 4, v98
    v_lshl_add_u32 v98, v5, 8, v98
    s_lshl_b32 s72, s3, 12
    s_add_u32 s72, s72, 131072
    v_add_u32 v92, s72, v98
    v_xor_b32 v93, 64, v92
    v_xor_b32 v94, 128, v92
    v_xor_b32 v95, 192, v92
    v_xor_b32 v10, v5, v96
    v_lshlrev_b32 v10, 4, v10
    v_lshl_add_u32 v10, v96, 8, v10
    v_add_u32 v10, 131072, v10
    v_bfe_u32 v98, v1, 2, 1
    v_lshlrev_b32 v98, 7, v98
    v_and_b32 v99, 3, v1
    v_add_lshl_u32 v98, v98, v99, 7
    s_lshl_b32 s72, s17, 9
    s_add_u32 s72, s72, 17104896
    buffer_load_dword v99, v98, s[4:7], s72 offen sc1
    buffer_load_dwordx2 v[90:91], v97, s[4:7], s66 offen sc1
    s_waitcnt vmcnt(0)
    v_cmp_ne_u32 vcc, s56, v99
    s_nop 0
    s_cbranch_vccnz L_slow24
L_back24:
    s_add_u32 s62, s71, 6291456
    buffer_load_dwordx2 v[80:81], v11, s[4:7], s62 offen sc1
    s_add_u32 s62, s71, 6815744
    buffer_load_dwordx2 v[82:83], v11, s[4:7], s62 offen sc1
    s_add_u32 s62, s71, 7340032
    buffer_load_dwordx2 v[84:85], v11, s[4:7], s62 offen sc1
    s_add_u32 s62, s71, 7864320
    buffer_load_dwordx2 v[86:87], v11, s[4:7], s62 offen sc1
    v_max_u32 v14, v90, v91
    v_cmp_eq_u32 vcc, -1, v14
    s_nop 0
    s_cbranch_vccnz L_slow25
L_back25:
    v_lshlrev_b32 v88, 16, v90
    v_and_b32 v89, s57, v90
    v_lshlrev_b32 v90, 16, v91
    v_and_b32 v91, s57, v91
    v_min_u32 v9, 13, v1
    v_lshlrev_b32 v9, 7, v9
    s_add_u32 s62, s25, 17170432
    buffer_load_dword v15, v9, s[4:7], s62 offen sc1
    s_waitcnt vmcnt(0)
    v_cmp_ne_u32 vcc, s56, v15
    s_nop 0
    s_cbranch_vccnz L_slow26
L_back26:
    s_add_u32 s63, s24, 0
    buffer_load_dwordx4 a[0:3], v2, s[4:7], s63 offen offset:0 sc1
    buffer_load_dwordx4 a[4:7], v2, s[4:7], s63 offen offset:1024 sc1
    buffer_load_dwordx4 a[8:11], v2, s[4:7], s63 offen offset:2048 sc1
    buffer_load_dwordx4 a[12:15], v2, s[4:7], s63 offen offset:3072 sc1
    s_add_u32 s63, s24, 4096
    buffer_load_dwordx4 a[16:19], v2, s[4:7], s63 offen offset:0 sc1
    buffer_load_dwordx4 a[20:23], v2, s[4:7], s63 offen offset:1024 sc1
    buffer_load_dwordx4 a[24:27], v2, s[4:7], s63 offen offset:2048 sc1
    buffer_load_dwordx4 a[28:31], v2, s[4:7], s63 offen offset:3072 sc1
    s_add_u32 s63, s24, 8192
    buffer_load_dwordx4 a[32:35], v2, s[4:7], s63 offen offset:0 sc1
    buffer_load_dwordx4 a[36:39], v2, s[4:7], s63 offen offset:1024 sc1
    buffer_load_dwordx4 a[40:43], v2, s[4:7], s63 offen offset:2048 sc1
    buffer_load_dwordx4 a[44:47], v2, s[4:7], s63 offen offset:3072 sc1
    s_add_u32 s63, s24, 12288
    buffer_load_dwordx4 a[48:51], v2, s[4:7], s63 offen offset:0 sc1
    buffer_load_dwordx4 a[52:55], v2, s[4:7], s63 offen offset:1024 sc1
    s_add_u32 s63, s24, 1835008
    buffer_load_dwordx4 a[56:59], v2, s[4:7], s63 offen offset:0 sc1
    buffer_load_dwordx4 a[60:63], v2, s[4:7], s63 offen offset:1024 sc1
    v_min_u32 v13, 13, v1
    v_lshlrev_b32 v13, 7, v13
    s_add_u32 s62, s25, 17301504
    buffer_load_dword v12, v13, s[4:7], s62 offen sc1
    s_waitcnt vmcnt(0) lgkmcnt(0)
    s_nop 4
    s_branch L_gemm2
L_slow1:
    s_nop 7
    s_nop 7
    s_mov_b32 s33, 0
    s_mov_b32 s23, m0
L_sl1:
    s_sleep 4
    s_mov_b32 s62, 16973824
    buffer_load_dword v239, v148, s[4:7], s62 offen sc1
    s_waitcnt vmcnt(0)
    v_cmp_ne_u32 vcc, s56, v239
    s_add_u32 s33, s33, 1
    s_cmp_ge_u32 s33, 20000
    s_cbranch_scc1 L_sx1
    s_cbranch_vccnz L_sl1
L_sx1:
    s_mov_b32 m0, s23
    s_nop 4
    s_branch L_back1
L_slow2:
    s_nop 7
    s_nop 7
    s_mov_b32 s33, 0
    s_mov_b32 s23, m0
L_sl2:
    s_sleep 4
    buffer_load_dwordx4 v[16:19], v134, s[4:7], s30 offen sc1
    buffer_load_dwordx4 v[20:23], v134, s[4:7], s31 offen sc1
    s_waitcnt vmcnt(0)
    v_max3_u32 v29, v16, v17, v18
    v_max3_u32 v29, v29, v19, v20
    v_max3_u32 v29, v29, v21, v22
    v_max_u32 v29, v29, v23
    v_cmp_eq_u32 vcc, -1, v29
    s_add_u32 s33, s33, 1
    s_cmp_ge_u32 s33, 20000
    s_cbranch_scc1 L_sx2
    s_cbranch_vccnz L_sl2
L_sx2:
    s_mov_b32 m0, s23
    s_nop 4
    s_branch L_back2
L_slow3:
    s_nop 7
    s_nop 7
    s_mov_b32 s33, 0
    s_mov_b32 s23, m0
L_sl3:
    s_sleep 4
    s_mov_b32 s62, 16777216
    buffer_load_dwordx4 v[176:179], v150, s[4:7], s62 offen offset:0 sc1
    buffer_load_dwordx4 v[160:163], v150, s[4:7], s62 offen offset:2048 sc1
    s_mov_b32 s62, 16781312
    buffer_load_dwordx4 v[164:167], v150, s[4:7], s62 offen offset:0 sc1
    buffer_load_dwordx4 v[24:27], v150, s[4:7], s62 offen offset:2048 sc1
    s_mov_b32 s62, 16785408
    buffer_load_dwordx4 v[28:31], v150, s[4:7], s62 offen offset:0 sc1
    s_waitcnt vmcnt(0)
    v_max3_u32 v96, v176, v177, v178
    v_max3_u32 v96, v96, v179, v160
    v_max3_u32 v96, v96, v161, v162
    v_max3_u32 v96, v96, v163, v164
    v_max3_u32 v96, v96, v165, v166
    v_max3_u32 v96, v96, v167, v24
    v_max3_u32 v96, v96, v25, v26
    v_max3_u32 v96, v96, v27, v28
    v_max3_u32 v96, v96, v29, v30
    v_max_u32 v96, v96, v31
    v_cmp_eq_u32 vcc, -1, v96
    s_add_u32 s33, s33, 1
    s_cmp_ge_u32 s33, 20000
    s_cbranch_scc1 L_sx3
    s_cbranch_vccnz L_sl3
L_sx3:
    s_mov_b32 m0, s23
    s_nop 4
    s_branch L_back3
L_slow4:
    s_nop 7
    s_nop 7
    s_mov_b32 s33, 0
    s_mov_b32 s23, m0
L_sl4:
    s_sleep 4
    s_add_u32 s62, s32, 0
    buffer_load_dwordx4 v[20:23], v151, s[4:7], s62 offen sc1
    s_waitcnt vmcnt(0)
    v_max3_u32 v96, v20, v21, v22
    v_max_u32 v96, v96, v23
    v_cmp_eq_u32 vcc, -1, v96
    s_add_u32 s33, s33, 1
    s_cmp_ge_u32 s33, 20000
    s_cbranch_scc1 L_sx4
    s_cbranch_vccnz L_sl4
L_sx4:
    s_mov_b32 m0, s23
    s_nop 4
    s_branch L_back4
L_slow5:
    s_nop 7
    s_nop 7
    s_mov_b32 s33, 0
    s_mov_b32 s23, m0
L_sl5:
    s_sleep 4
    s_mov_b32 s62, 17039360
    buffer_load_dword v236, v148, s[4:7], s62 offen sc1
    s_waitcnt vmcnt(0)
    v_cmp_ne_u32 vcc, s56, v236
    s_add_u32 s33, s33, 1
    s_cmp_ge_u32 s33, 20000
    s_cbranch_scc1 L_sx5
    s_cbranch_vccnz L_sl5
L_sx5:
    s_mov_b32 m0, s23
    s_nop 4
    s_branch L_back5
L_slow6:
    s_nop 7
    s_nop 7
    s_mov_b32 s33, 0
    s_mov_b32 s23, m0
L_sl6:
    s_sleep 4
    s_add_u32 m0, s69, 32768
    s_add_u32 s62, s70, 0
    buffer_load_dwordx4 v108, s[4:7], s62 offen offset:0 sc1 lds
    buffer_load_dwordx4 v109, s[4:7], s62 offen offset:1024 sc1 lds
    buffer_load_dwordx4 v110, s[4:7], s62 offen offset:2048 sc1 lds
    buffer_load_dwordx4 v111, s[4:7], s62 offen offset:3072 sc1 lds
    s_waitcnt vmcnt(0)
    ds_read_b128 v[64:67], v3 offset:32768
    ds_read_b128 v[68:71], v3 offset:33792
    ds_read_b128 v[72:75], v3 offset:34816
    ds_read_b128 v[76:79], v3 offset:35840
    s_waitcnt lgkmcnt(0)
    v_max3_u32 v14, v64, v65, v66
    v_max3_u32 v14, v14, v67, v68
    v_max3_u32 v14, v14, v69, v70
    v_max3_u32 v14, v14, v71, v72
    v_max3_u32 v14, v14, v73, v74
    v_max3_u32 v14, v14, v75, v76
    v_max3_u32 v14, v14, v77, v78
    v_max_u32 v14, v14, v79
    v_cmp_eq_u32 vcc, -1, v14
    s_add_u32 s33, s33, 1
    s_cmp_ge_u32 s33, 20000
    s_cbranch_scc1 L_sx6
    s_cbranch_vccnz L_sl6
L_sx6:
    s_mov_b32 m0, s23
    s_nop 4
    s_branch L_back6
L_slow7:
    s_nop 7
    s_nop 7
    s_mov_b32 s33, 0
    s_mov_b32 s23, m0
L_sl7:
    s_sleep 4
    s_add_u32 s62, s32, 1048576
    buffer_load_dwordx4 v[156:159], v151, s[4:7], s62 offen sc1
    s_waitcnt vmcnt(0)
    v_max3_u32 v14, v156, v157, v158
    v_max_u32 v14, v14, v159
    v_cmp_eq_u32 vcc, -1, v14
    s_add_u32 s33, s33, 1
    s_cmp_ge_u32 s33, 20000
    s_cbranch_scc1 L_sx7
    s_cbranch_vccnz L_sl7
L_sx7:
    s_mov_b32 m0, s23
    s_nop 4
    s_branch L_back7
L_slow8:
    s_nop 7
    s_nop 7
    s_mov_b32 s33, 0
    s_mov_b32 s23, m0
L_sl8:
    s_sleep 4
    s_add_u32 m0, s69, 49152
    s_add_u32 s62, s70, 262144
    buffer_load_dwordx4 v108, s[4:7], s62 offen offset:0 sc1 lds
    buffer_load_dwordx4 v109, s[4:7], s62 offen offset:1024 sc1 lds
    buffer_load_dwordx4 v110, s[4:7], s62 offen offset:2048 sc1 lds
    buffer_load_dwordx4 v111, s[4:7], s62 offen offset:3072 sc1 lds
    s_waitcnt vmcnt(0)
    ds_read_b128 v[64:67], v3 offset:49152
    ds_read_b128 v[68:71], v3 offset:50176
    ds_read_b128 v[72:75], v3 offset:51200
    ds_read_b128 v[76:79], v3 offset:52224
    s_waitcnt lgkmcnt(0)
    v_max3_u32 v14, v64, v65, v66
    v_max3_u32 v14, v14, v67, v68
    v_max3_u32 v14, v14, v69, v70
    v_max3_u32 v14, v14, v71, v72
    v_max3_u32 v14, v14, v73, v74
    v_max3_u32 v14, v14, v75, v76
    v_max3_u32 v14, v14, v77, v78
    v_max_u32 v14, v14, v79
    v_cmp_eq_u32 vcc, -1, v14
    s_add_u32 s33, s33, 1
    s_cmp_ge_u32 s33, 20000
    s_cbranch_scc1 L_sx8
    s_cbranch_vccnz L_sl8
L_sx8:
    s_mov_b32 m0, s23
    s_nop 4
    s_branch L_back8
L_slow9:
    s_nop 7
    s_nop 7
    s_mov_b32 s33, 0
    s_mov_b32 s23, m0
L_sl9:
    s_sleep 4
    s_add_u32 m0, s69, 0
    s_add_u32 s62, s70, 524288
    buffer_load_dwordx4 v108, s[4:7], s62 offen offset:0 sc1 lds
    buffer_load_dwordx4 v109, s[4:7], s62 offen offset:1024 sc1 lds
    buffer_load_dwordx4 v110, s[4:7], s62 offen offset:2048 sc1 lds
    buffer_load_dwordx4 v111, s[4:7], s62 offen offset:3072 sc1 lds
    s_waitcnt vmcnt(0)
    ds_read_b128 v[64:67], v3 offset:0
    ds_read_b128 v[68:71], v3 offset:1024
    ds_read_b128 v[72:75], v3 offset:2048
    ds_read_b128 v[76:79], v3 offset:3072
    s_waitcnt lgkmcnt(0)
    v_max3_u32 v14, v64, v65, v66
    v_max3_u32 v14, v14, v67, v68
    v_max3_u32 v14, v14, v69, v70
    v_max3_u32 v14, v14, v71, v72
    v_max3_u32 v14, v14, v73, v74
    v_max3_u32 v14, v14, v75, v76
    v_max3_u32 v14, v14, v77, v78
    v_max_u32 v14, v14, v79
    v_cmp_eq_u32 vcc, -1, v14
    s_add_u32 s33, s33, 1
    s_cmp_ge_u32 s33, 20000
    s_cbranch_scc1 L_sx9
    s_cbranch_vccnz L_sl9
L_sx9:
    s_mov_b32 m0, s23
    s_nop 4
    s_branch L_back9
L_slow10:
    s_nop 7
    s_nop 7
    s_mov_b32 s33, 0
    s_mov_b32 s23, m0
L_sl10:
    s_sleep 4
    s_add_u32 m0, s69, 16384
    s_add_u32 s62, s70, 786432
    buffer_load_dwordx4 v108, s[4:7], s62 offen offset:0 sc1 lds
    buffer_load_dwordx4 v109, s[4:7], s62 offen offset:1024 sc1 lds
    buffer_load_dwordx4 v110, s[4:7], s62 offen offset:2048 sc1 lds
    buffer_load_dwordx4 v111, s[4:7], s62 offen offset:3072 sc1 lds
    s_waitcnt vmcnt(0)
    ds_read_b128 v[64:67], v3 offset:16384
    ds_read_b128 v[68:71], v3 offset:17408
    ds_read_b128 v[72:75], v3 offset:18432
    ds_read_b128 v[76:79], v3 offset:19456
    s_waitcnt lgkmcnt(0)
    v_max3_u32 v14, v64, v65, v66
    v_max3_u32 v14, v14, v67, v68
    v_max3_u32 v14, v14, v69, v70
    v_max3_u32 v14, v14, v71, v72
    v_max3_u32 v14, v14, v73, v74
    v_max3_u32 v14, v14, v75, v76
    v_max3_u32 v14, v14, v77, v78
    v_max_u32 v14, v14, v79
    v_cmp_eq_u32 vcc, -1, v14
    s_add_u32 s33, s33, 1
    s_cmp_ge_u32 s33, 20000
    s_cbranch_scc1 L_sx10
    s_cbranch_vccnz L_sl10
L_sx10:
    s_mov_b32 m0, s23
    s_nop 4
    s_branch L_back10
L_slow11:
    s_nop 7
    s_nop 7
    s_mov_b32 s33, 0
    s_mov_b32 s23, m0
L_sl11:
    s_sleep 4
    s_add_u32 m0, s69, 32768
    s_add_u32 s62, s70, 1048576
    buffer_load_dwordx4 v108, s[4:7], s62 offen offset:0 sc1 lds
    buffer_load_dwordx4 v109, s[4:7], s62 offen offset:1024 sc1 lds
    buffer_load_dwordx4 v110, s[4:7], s62 offen offset:2048 sc1 lds
    buffer_load_dwordx4 v111, s[4:7], s62 offen offset:3072 sc1 lds
    s_waitcnt vmcnt(0)
    ds_read_b128 v[64:67], v3 offset:32768
    ds_read_b128 v[68:71], v3 offset:33792
    ds_read_b128 v[72:75], v3 offset:34816
    ds_read_b128 v[76:79], v3 offset:35840
    s_waitcnt lgkmcnt(0)
    v_max3_u32 v14, v64, v65, v66
    v_max3_u32 v14, v14, v67, v68
    v_max3_u32 v14, v14, v69, v70
    v_max3_u32 v14, v14, v71, v72
    v_max3_u32 v14, v14, v73, v74
    v_max3_u32 v14, v14, v75, v76
    v_max3_u32 v14, v14, v77, v78
    v_max_u32 v14, v14, v79
    v_cmp_eq_u32 vcc, -1, v14
    s_add_u32 s33, s33, 1
    s_cmp_ge_u32 s33, 20000
    s_cbranch_scc1 L_sx11
    s_cbranch_vccnz L_sl11
L_sx11:
    s_mov_b32 m0, s23
    s_nop 4
    s_branch L_back11
L_slow12:
    s_nop 7
    s_nop 7
    s_mov_b32 s33, 0
    s_mov_b32 s23, m0
L_sl12:
    s_sleep 4
    s_add_u32 m0, s69, 49152
    s_add_u32 s62, s70, 1310720
    buffer_load_dwordx4 v108, s[4:7], s62 offen offset:0 sc1 lds
    buffer_load_dwordx4 v109, s[4:7], s62 offen offset:1024 sc1 lds
    buffer_load_dwordx4 v110, s[4:7], s62 offen offset:2048 sc1 lds
    buffer_load_dwordx4 v111, s[4:7], s62 offen offset:3072 sc1 lds
    s_waitcnt vmcnt(0)
    ds_read_b128 v[64:67], v3 offset:49152
    ds_read_b128 v[68:71], v3 offset:50176
    ds_read_b128 v[72:75], v3 offset:51200
    ds_read_b128 v[76:79], v3 offset:52224
    s_waitcnt lgkmcnt(0)
    v_max3_u32 v14, v64, v65, v66
    v_max3_u32 v14, v14, v67, v68
    v_max3_u32 v14, v14, v69, v70
    v_max3_u32 v14, v14, v71, v72
    v_max3_u32 v14, v14, v73, v74
    v_max3_u32 v14, v14, v75, v76
    v_max3_u32 v14, v14, v77, v78
    v_max_u32 v14, v14, v79
    v_cmp_eq_u32 vcc, -1, v14
    s_add_u32 s33, s33, 1
    s_cmp_ge_u32 s33, 20000
    s_cbranch_scc1 L_sx12
    s_cbranch_vccnz L_sl12
L_sx12:
    s_mov_b32 m0, s23
    s_nop 4
    s_branch L_back12
L_slow13:
    s_nop 7
    s_nop 7
    s_mov_b32 s33, 0
    s_mov_b32 s23, m0
L_sl13:
    s_sleep 4
    s_add_u32 m0, s69, 0
    s_add_u32 s62, s70, 1572864
    buffer_load_dwordx4 v108, s[4:7], s62 offen offset:0 sc1 lds
    buffer_load_dwordx4 v109, s[4:7], s62 offen offset:1024 sc1 lds
    buffer_load_dwordx4 v110, s[4:7], s62 offen offset:2048 sc1 lds
    buffer_load_dwordx4 v111, s[4:7], s62 offen offset:3072 sc1 lds
    s_waitcnt vmcnt(0)
    ds_read_b128 v[64:67], v3 offset:0
    ds_read_b128 v[68:71], v3 offset:1024
    ds_read_b128 v[72:75], v3 offset:2048
    ds_read_b128 v[76:79], v3 offset:3072
    s_waitcnt lgkmcnt(0)
    v_max3_u32 v14, v64, v65, v66
    v_max3_u32 v14, v14, v67, v68
    v_max3_u32 v14, v14, v69, v70
    v_max3_u32 v14, v14, v71, v72
    v_max3_u32 v14, v14, v73, v74
    v_max3_u32 v14, v14, v75, v76
    v_max3_u32 v14, v14, v77, v78
    v_max_u32 v14, v14, v79
    v_cmp_eq_u32 vcc, -1, v14
    s_add_u32 s33, s33, 1
    s_cmp_ge_u32 s33, 20000
    s_cbranch_scc1 L_sx13
    s_cbranch_vccnz L_sl13
L_sx13:
    s_mov_b32 m0, s23
    s_nop 4
    s_branch L_back13
L_slow14:
    s_nop 7
    s_nop 7
    s_mov_b32 s33, 0
    s_mov_b32 s23, m0
L_sl14:
    s_sleep 4
    v_bfe_u32 v98, v1, 2, 1
    v_lshlrev_b32 v98, 7, v98
    v_and_b32 v99, 3, v1
    v_add_lshl_u32 v98, v98, v99, 7
    s_lshl_b32 s62, s17, 9
    s_add_u32 s62, s62, 17104896
    buffer_load_dword v99, v98, s[4:7], s62 offen sc1
    s_waitcnt vmcnt(0)
    v_cmp_ne_u32 vcc, s56, v99
    s_add_u32 s33, s33, 1
    s_cmp_ge_u32 s33, 20000
    s_cbranch_scc1 L_sx14
    s_cbranch_vccnz L_sl14
L_sx14:
    s_mov_b32 m0, s23
    s_nop 4
    s_branch L_back14
L_slow15:
    s_nop 7
    s_nop 7
    s_mov_b32 s33, 0
    s_mov_b32 s23, m0
L_sl15:
    s_sleep 4
    buffer_load_dwordx2 v[90:91], v97, s[4:7], s66 offen sc1
    s_waitcnt vmcnt(0)
    v_max_u32 v14, v90, v91
    v_cmp_eq_u32 vcc, -1, v14
    s_add_u32 s33, s33, 1
    s_cmp_ge_u32 s33, 20000
    s_cbranch_scc1 L_sx15
    s_cbranch_vccnz L_sl15
L_sx15:
    s_mov_b32 m0, s23
    s_nop 4
    s_branch L_back15
L_slow16:
    s_nop 7
    s_nop 7
    s_mov_b32 s33, 0
    s_mov_b32 s23, m0
L_sl16:
    s_sleep 4
    s_add_u32 m0, s69, 16384
    s_add_u32 s62, s70, 1835008
    buffer_load_dwordx4 v108, s[4:7], s62 offen offset:0 sc1 lds
    buffer_load_dwordx4 v109, s[4:7], s62 offen offset:1024 sc1 lds
    buffer_load_dwordx4 v110, s[4:7], s62 offen offset:2048 sc1 lds
    buffer_load_dwordx4 v111, s[4:7], s62 offen offset:3072 sc1 lds
    s_waitcnt vmcnt(0)
    ds_read_b128 v[64:67], v3 offset:16384
    ds_read_b128 v[68:71], v3 offset:17408
    ds_read_b128 v[72:75], v3 offset:18432
    ds_read_b128 v[76:79], v3 offset:19456
    s_waitcnt lgkmcnt(0)
    v_max3_u32 v14, v64, v65, v66
    v_max3_u32 v14, v14, v67, v68
    v_max3_u32 v14, v14, v69, v70
    v_max3_u32 v14, v14, v71, v72
    v_max3_u32 v14, v14, v73, v74
    v_max3_u32 v14, v14, v75, v76
    v_max3_u32 v14, v14, v77, v78
    v_max_u32 v14, v14, v79
    v_cmp_eq_u32 vcc, -1, v14
    s_add_u32 s33, s33, 1
    s_cmp_ge_u32 s33, 20000
    s_cbranch_scc1 L_sx16
    s_cbranch_vccnz L_sl16
L_sx16:
    s_mov_b32 m0, s23
    s_nop 4
    s_branch L_back16
L_slow17:
    s_nop 7
    s_nop 7
    s_mov_b32 s33, 0
    s_mov_b32 s23, m0
L_sl17:
    s_sleep 4
    v_min_u32 v13, 13, v1
    v_lshlrev_b32 v13, 7, v13
    s_add_u32 s62, s25, 17563648
    buffer_load_dword v12, v13, s[4:7], s62 offen sc1
    s_waitcnt vmcnt(0)
    v_cmp_ne_u32 vcc, s56, v12
    s_add_u32 s33, s33, 1
    s_cmp_ge_u32 s33, 20000
    s_cbranch_scc1 L_sx17
    s_cbranch_vccnz L_sl17
L_sx17:
    s_mov_b32 m0, s23
    s_nop 4
    s_branch L_back17
L_slow18:
    s_nop 7
    s_nop 7
    s_mov_b32 s33, 0
    s_mov_b32 s23, m0
L_sl18:
    s_sleep 4
    v_min_u32 v9, 13, v1
    v_lshlrev_b32 v9, 7, v9
    s_add_u32 s62, s25, 17170432
    buffer_load_dword v15, v9, s[4:7], s62 offen sc1
    s_waitcnt vmcnt(0)
    v_cmp_ne_u32 vcc, s56, v15
    s_add_u32 s33, s33, 1
    s_cmp_ge_u32 s33, 20000
    s_cbranch_scc1 L_sx18
    s_cbranch_vccnz L_sl18
L_sx18:
    s_mov_b32 m0, s23
    s_nop 4
    s_branch L_back18
L_slow19:
    s_nop 7
    s_nop 7
    s_mov_b32 s33, 0
    s_mov_b32 s23, m0
L_sl19:
    s_sleep 4
    v_min_u32 v13, 13, v1
    v_lshlrev_b32 v13, 7, v13
    s_add_u32 s62, s25, 17301504
    buffer_load_dword v12, v13, s[4:7], s62 offen sc1
    s_waitcnt vmcnt(0)
    v_cmp_ne_u32 vcc, s56, v12
    s_add_u32 s33, s33, 1
    s_cmp_ge_u32 s33, 20000
    s_cbranch_scc1 L_sx19
    s_cbranch_vccnz L_sl19
L_sx19:
    s_mov_b32 m0, s23
    s_nop 4
    s_branch L_back19
L_slow20:
    s_nop 7
    s_nop 7
    s_mov_b32 s33, 0
    s_mov_b32 s23, m0
L_sl20:
    s_sleep 4
    s_add_u32 s62, s24, 5505024
    buffer_load_dwordx4 v[64:67], v2, s[4:7], s62 offen sc1
    s_add_u32 s62, s24, 5506048
    buffer_load_dwordx4 v[68:71], v2, s[4:7], s62 offen sc1
    s_add_u32 s62, s24, 5507072
    buffer_load_dwordx4 v[72:75], v2, s[4:7], s62 offen sc1
    s_add_u32 s62, s24, 5508096
    buffer_load_dwordx4 v[76:79], v2, s[4:7], s62 offen sc1
    s_add_u32 s62, s24, 5509120
    buffer_load_dwordx4 v[96:99], v2, s[4:7], s62 offen sc1
    s_waitcnt vmcnt(0)
    v_max3_u32 v1, v64, v65, v66
    v_max3_u32 v1, v1, v67, v68
    v_max3_u32 v1, v1, v69, v70
    v_max3_u32 v1, v1, v71, v72
    v_max3_u32 v1, v1, v73, v74
    v_max3_u32 v1, v1, v75, v76
    v_max3_u32 v1, v1, v77, v78
    v_max3_u32 v1, v1, v79, v96
    v_max3_u32 v1, v1, v97, v98
    v_max_u32 v1, v1, v99
    v_cmp_eq_u32 vcc, -1, v1
    s_add_u32 s33, s33, 1
    s_cmp_ge_u32 s33, 20000
    s_cbranch_scc1 L_sx20
    s_cbranch_vccnz L_sl20
L_sx20:
    s_mov_b32 m0, s23
    s_nop 4
    s_branch L_back20
L_slow21:
    s_nop 7
    s_nop 7
    s_mov_b32 s33, 0
    s_mov_b32 s23, m0
L_sl21:
    s_sleep 4
    s_add_u32 s62, s24, 5510144
    buffer_load_dwordx4 v[100:103], v2, s[4:7], s62 offen sc1
    s_add_u32 s62, s24, 5511168
    buffer_load_dwordx4 v[104:107], v2, s[4:7], s62 offen sc1
    s_add_u32 s62, s24, 5512192
    buffer_load_dwordx4 v[108:111], v2, s[4:7], s62 offen sc1
    s_add_u32 s62, s24, 5513216
    buffer_load_dwordx4 v[4:7], v2, s[4:7], s62 offen sc1
    s_add_u32 s62, s24, 5514240
    buffer_load_dwordx4 v[12:15], v2, s[4:7], s62 offen sc1
    s_waitcnt vmcnt(0)
    v_max3_u32 v1, v100, v101, v102
    v_max3_u32 v1, v1, v103, v104
    v_max3_u32 v1, v1, v105, v106
    v_max3_u32 v1, v1, v107, v108
    v_max3_u32 v1, v1, v109, v110
    v_max3_u32 v1, v1, v111, v4
    v_max3_u32 v1, v1, v5, v6
    v_max3_u32 v1, v1, v7, v12
    v_max3_u32 v1, v1, v13, v14
    v_max_u32 v1, v1, v15
    v_cmp_eq_u32 vcc, -1, v1
    s_add_u32 s33, s33, 1
    s_cmp_ge_u32 s33, 20000
    s_cbranch_scc1 L_sx21
    s_cbranch_vccnz L_sl21
L_sx21:
    s_mov_b32 m0, s23
    s_nop 4
    s_branch L_back21
L_slow22:
    s_nop 7
    s_nop 7
    s_mov_b32 s33, 0
    s_mov_b32 s23, m0
L_sl22:
    s_sleep 4
    s_add_u32 s62, s24, 5515264
    buffer_load_dwordx4 v[116:119], v2, s[4:7], s62 offen sc1
    s_add_u32 s62, s24, 5516288
    buffer_load_dwordx4 v[120:123], v2, s[4:7], s62 offen sc1
    s_add_u32 s62, s24, 5517312
    buffer_load_dwordx4 v[112:115], v2, s[4:7], s62 offen sc1
    s_add_u32 s62, s24, 5518336
    buffer_load_dwordx4 v[124:127], v2, s[4:7], s62 offen sc1
    s_waitcnt vmcnt(0)
    v_max3_u32 v1, v116, v117, v118
    v_max3_u32 v1, v1, v119, v120
    v_max3_u32 v1, v1, v121, v122
    v_max3_u32 v1, v1, v123, v112
    v_max3_u32 v1, v1, v113, v114
    v_max3_u32 v1, v1, v115, v124
    v_max3_u32 v1, v1, v125, v126
    v_max_u32 v1, v1, v127
    v_cmp_eq_u32 vcc, -1, v1
    s_add_u32 s33, s33, 1
    s_cmp_ge_u32 s33, 20000
    s_cbranch_scc1 L_sx22
    s_cbranch_vccnz L_sl22
L_sx22:
    s_mov_b32 m0, s23
    s_nop 4
    s_branch L_back22
L_slow23:
    s_nop 7
    s_nop 7
    s_mov_b32 s33, 0
    s_mov_b32 s23, m0
L_sl23:
    s_sleep 4
    s_add_u32 s62, s32, 1048576
    buffer_load_dwordx4 v[156:159], v151, s[4:7], s62 offen sc1
    s_waitcnt vmcnt(0)
    v_max3_u32 v14, v156, v157, v158
    v_max_u32 v14, v14, v159
    v_cmp_eq_u32 vcc, -1, v14
    s_add_u32 s33, s33, 1
    s_cmp_ge_u32 s33, 20000
    s_cbranch_scc1 L_sx23
    s_cbranch_vccnz L_sl23
L_sx23:
    s_mov_b32 m0, s23
    s_nop 4
    s_branch L_back23
L_slow24:
    s_nop 7
    s_nop 7
    s_mov_b32 s33, 0
    s_mov_b32 s23, m0
L_sl24:
    s_sleep 4
    v_bfe_u32 v98, v1, 2, 1
    v_lshlrev_b32 v98, 7, v98
    v_and_b32 v99, 3, v1
    v_add_lshl_u32 v98, v98, v99, 7
    s_lshl_b32 s62, s17, 9
    s_add_u32 s62, s62, 17104896
    buffer_load_dword v99, v98, s[4:7], s62 offen sc1
    s_waitcnt vmcnt(0)
    v_cmp_ne_u32 vcc, s56, v99
    s_add_u32 s33, s33, 1
    s_cmp_ge_u32 s33, 20000
    s_cbranch_scc1 L_sx24
    s_cbranch_vccnz L_sl24
L_sx24:
    s_mov_b32 m0, s23
    s_nop 4
    s_branch L_back24
L_slow25:
    s_nop 7
    s_nop 7
    s_mov_b32 s33, 0
    s_mov_b32 s23, m0
L_sl25:
    s_sleep 4
    buffer_load_dwordx2 v[90:91], v97, s[4:7], s66 offen sc1
    s_waitcnt vmcnt(0)
    v_max_u32 v14, v90, v91
    v_cmp_eq_u32 vcc, -1, v14
    s_add_u32 s33, s33, 1
    s_cmp_ge_u32 s33, 20000
    s_cbranch_scc1 L_sx25
    s_cbranch_vccnz L_sl25
L_sx25:
    s_mov_b32 m0, s23
    s_nop 4
    s_branch L_back25
L_slow26:
    s_nop 7
    s_nop 7
    s_mov_b32 s33, 0
    s_mov_b32 s23, m0
L_sl26:
    s_sleep 8
    v_min_u32 v9, 13, v1
    v_lshlrev_b32 v9, 7, v9
    s_add_u32 s62, s25, 17170432
    buffer_load_dword v15, v9, s[4:7], s62 offen sc1
    s_waitcnt vmcnt(0)
    v_cmp_ne_u32 vcc, s56, v15
    s_add_u32 s33, s33, 1
    s_cmp_ge_u32 s33, 20000
    s_cbranch_scc1 L_sx26
    s_cbranch_vccnz L_sl26
L_sx26:
    s_mov_b32 m0, s23
    s_nop 4
    s_branch L_back26
L_codeend:
.section .rodata,"a"
.p2align 6
.amdhsa_kernel adaLN_cond__ssm_conv_h3__glu_gated_bilinear__prompt_kernel
  .amdhsa_next_free_vgpr 512
  .amdhsa_next_free_sgpr 102
  .amdhsa_accum_offset 256
  .amdhsa_group_segment_fixed_size 0
  .amdhsa_kernarg_size 120
  .amdhsa_user_sgpr_count 2
  .amdhsa_user_sgpr_kernarg_segment_ptr 1
  .amdhsa_system_sgpr_workgroup_id_x 1
  .amdhsa_float_denorm_mode_32 3
.end_amdhsa_kernel
```
